```python
import torch

def _softmax(x, axis=-1):
    return torch.softmax(x, dim=axis)
def _gelu(x):
    return torch.nn.functional.gelu(x, approximate="tanh")
def _silu(x):
    return torch.nn.functional.silu(x)
def _sigmoid(x):
    return torch.sigmoid(x)
def _layernorm(x, axis=-1, eps=1e-5):
    m = x.mean(dim=axis, keepdim=True)
    v = x.var(dim=axis, keepdim=True, unbiased=False)
    return (x - m) / torch.sqrt(v + eps)
def _scatter_add(tgt, idx, src, axis=0):
    return tgt.clone().index_add_(axis, idx, src)
def _segment_sum(src, seg, n):
    out = torch.zeros((n,) + src.shape[1:], dtype=src.dtype)
    return out.index_add_(0, seg, src)
def _pad(x, pw):
    flat = tuple(v for pair in reversed(pw) for v in pair)
    return torch.nn.functional.pad(x, flat)

kernel_name = 'sequential_preLN__mha_block__glu_gated_swiglu__prompt'

def setup_inputs():

    _w = (lambda a: (lambda t: t.to(torch.bfloat16) if t.is_floating_point() else t)(torch.as_tensor(a)))
    def _A_setup():
        B, S, D, H = 1, 2048, 640, 32
        return {
            "x": _w((lambda *s: torch.randn(*s, dtype=torch.bfloat16) * 0.05)(B, S, D)),
            "wqkv": _w((lambda *s: torch.randn(*s, dtype=torch.bfloat16) * 0.05)(D, 3 * D)),
            "wo": _w((lambda *s: torch.randn(*s, dtype=torch.bfloat16) * 0.05)(D, D)),
        }
    _A_in = _A_setup()

    def _B_setup():
        B, S, D, F = 1, 2048, 640, 1536
        return {
            "x": _w((lambda *s: torch.randn(*s, dtype=torch.bfloat16) * 0.05)(B, S, D)),
            "w1": _w((lambda *s: torch.randn(*s, dtype=torch.bfloat16) * 0.4)(D, F) * (2.0 / D) ** 0.5),
            "w3": _w((lambda *s: torch.randn(*s, dtype=torch.bfloat16) * 0.4)(D, F) * (2.0 / D) ** 0.5),
            "w2": _w((lambda *s: torch.randn(*s, dtype=torch.bfloat16) * 0.4)(F, D) * (2.0 / F) ** 0.5),
        }
    _B_in = _B_setup()

    return {
        "A_x": _A_in["x"],
        "A_wqkv": _A_in["wqkv"],
        "A_wo": _A_in["wo"],
        "B_x": _B_in["x"],
        "B_w1": _B_in["w1"],
        "B_w3": _B_in["w3"],
        "B_w2": _B_in["w2"],
    }

def reference(A_x, A_wqkv, A_wo, B_x, B_w1, B_w3, B_w2):
    def _A_ref(x, wqkv, wo):
        B, S, D = x.shape
        H = 32
        Dh = D // H
        qkv = (lambda x, *d: x.permute(*d))((x @ wqkv).reshape(B, S, 3, H, Dh), 2, 0, 3, 1, 4)
        q, k, v = qkv[0], qkv[1], qkv[2]
        scores = torch.einsum("bhqd,bhkd->bhqk", q, k) * (Dh ** -0.5)
        p = _softmax(scores, axis=-1)
        o = torch.einsum("bhqk,bhkd->bhqd", p, v)
        return (lambda x, *d: x.permute(*d))(o, 0, 2, 1, 3).reshape(B, S, D) @ wo

    def _B_ref(x, w1, w3, w2):
        gate = torch.einsum("bsd,df->bsf", x, w1)
        up = torch.einsum("bsd,df->bsf", x, w3)
        h = _silu(gate) * up
        out = torch.einsum("bsf,fd->bsd", h, w2)
        return out

    x = A_x
    h = x + _A_ref(_layernorm(x, axis=-1), A_wqkv, A_wo)
    h2 = h + _B_ref(_layernorm(h, axis=-1), B_w1, B_w3, B_w2)
    return h2
```

```asm
; @launch kernel=block_kernel grid=(256,1,1) block=(512,1,1) lds=163840
.amdgcn_target "amdgcn-amd-amdhsa--gfx950"
.text
.globl block_kernel
.p2align 8
.type block_kernel,@function
block_kernel:
    s_cmp_ge_u32 s2, 256
    s_cbranch_scc1 L_block_kernel_end_4
    s_load_dwordx2 s[4:5], s[0:1], 0
    s_load_dwordx2 s[8:9], s[0:1], 8
    s_load_dwordx2 s[12:13], s[0:1], 72
    s_load_dwordx2 s[20:21], s[0:1], 64
    s_mov_b32 s6, 2621440
    s_mov_b32 s7, 0x00020000
    s_mov_b32 s10, 2457600
    s_mov_b32 s11, 0x00020000
    s_mov_b32 s14, 41943040
    s_mov_b32 s15, 0x00020000
    s_mov_b32 s22, 256
    s_mov_b32 s23, 0x00020000
    v_lshrrev_b32 v1, 6, v0
    v_and_b32 v2, 63, v0
    v_readfirstlane_b32 s26, v1
    s_lshr_b32 s38, s2, 3
    s_bfe_u32 s39, s2, 0x20001
    s_and_b32 s40, s2, 1
    s_lshl_b32 s27, s40, 3
    s_lshr_b32 s25, s38, 2
    s_add_u32 s25, s25, s27
    s_and_b32 s24, s38, 3
    s_lshl_b32 s27, s40, 1
    s_add_u32 s27, s27, s24
    s_cmp_ge_u32 s38, 28
    s_cmov_b32 s25, 7
    s_cmov_b32 s24, s27
    s_lshl_b32 s27, s39, 2
    s_add_u32 s24, s24, s27
    s_cmp_ge_u32 s2, 240
    s_cbranch_scc1 L_block_kernel_spare_2
    s_cmp_ge_u32 s26, 4
    s_cbranch_scc0 L_block_kernel_mf_6
    s_sub_u32 s26, s26, 4
    v_lshrrev_b32 v1, 3, v2
    v_mul_u32_u24 v1, 1280, v1
    v_and_b32 v6, 7, v2
    v_lshrrev_b32 v7, 4, v2
    v_xor_b32 v6, v6, v7
    v_lshl_add_u32 v8, v6, 4, v1
    v_xor_b32 v6, 4, v6
    v_lshl_add_u32 v9, v6, 4, v1
    v_add_u32 v9, 9216, v9
    v_add_u32 v10, 18432, v8
    v_add_u32 v11, 18432, v9
    s_lshl_b32 s30, s24, 2
    s_add_u32 s30, s30, s26
    s_mul_i32 s30, s30, 40960
    v_mul_u32_u24 v1, 3840, v7
    v_lshlrev_b32 v7, 2, v7
    v_and_b32 v6, 15, v2
    v_xor_b32 v6, v6, v7
    v_lshl_add_u32 v12, v6, 4, v1
    v_add_u32 v13, 14336, v12
    v_add_u32 v14, 28672, v12
    v_add_u32 v15, 43008, v12
    s_mul_i32 s31, s26, 61440
    s_lshl_b32 s27, s25, 8
    s_add_u32 s31, s31, s27
    s_lshl_b32 s32, s26, 12
    s_mov_b32 s34, 0
    s_add_u32 s35, s24, s25
    s_and_b32 s35, s35, 3
    s_mul_i32 s35, s35, 640
    s_lshr_b32 s35, s35, 8
    s_lshl_b32 s36, s35, 7
    s_add_u32 s30, s30, s36
    s_mul_i32 s36, s35, 245760
    s_add_u32 s31, s31, s36
    s_sub_u32 s35, 10, s35
    s_waitcnt lgkmcnt(0)
L_block_kernel_dma_7:
    s_mov_b32 m0, s32
    s_add_u32 s34, s34, 1
    buffer_load_dwordx4 v8, s[4:7], s30 offen offset:0 lds
    buffer_load_dwordx4 v9, s[4:7], s30 offen offset:1024 lds
    buffer_load_dwordx4 v10, s[4:7], s30 offen offset:2048 lds
    buffer_load_dwordx4 v11, s[4:7], s30 offen offset:3072 lds
    s_add_u32 m0, s32, 16384
    s_cmp_eq_u32 s34, s35
    s_cselect_b32 s37, -9, 1
    s_lshl_b32 s36, s37, 7
    s_mul_i32 s37, s37, 245760
    s_add_u32 s30, s30, s36
    buffer_load_dwordx4 v12, s[8:11], s31 offen offset:0 lds
    buffer_load_dwordx4 v13, s[8:11], s31 offen offset:1024 lds
    buffer_load_dwordx4 v14, s[8:11], s31 offen offset:2048 lds
    buffer_load_dwordx4 v15, s[8:11], s31 offen offset:3072 lds
    s_add_u32 s31, s31, s37
    s_add_u32 s32, s32, 32768
    s_and_b32 s32, s32, 0x1ffff
    s_cmp_lg_u32 s34, 8
    s_cbranch_scc1 L_block_kernel_b_9
    buffer_load_dword v3, off, s[20:23], 0 sc0 sc1
L_block_kernel_b_9:
    s_cmp_eq_u32 s34, 1
    s_cbranch_scc1 L_block_kernel_dma_7
    s_cmp_eq_u32 s34, 10
    s_cbranch_scc1 L_block_kernel_help_5
    s_bitcmp1_b32 768, s34
    s_cbranch_scc1 L_block_kernel_w_8
    s_waitcnt vmcnt(8)
L_block_kernel_w_8:
    s_waitcnt vmcnt(9)
    s_barrier
    s_branch L_block_kernel_dma_7
L_block_kernel_o_10:
L_block_kernel_mf_6:
    v_and_b32 v3, 31, v2
    v_lshrrev_b32 v4, 5, v2
    v_bfe_u32 v5, v3, 1, 3
    v_xor_b32 v5, v5, v4
    v_lshlrev_b32 v5, 4, v5
    v_lshl_add_u32 v5, v3, 7, v5
    s_lshr_b32 s27, s26, 1
    s_and_b32 s28, s26, 1
    s_lshl_b32 s29, s27, 13
    v_add_u32 v8, s29, v5
    v_xor_b32 v9, 32, v8
    v_xor_b32 v10, 64, v8
    v_xor_b32 v11, 0x60, v8
    v_xor_b32 v12, 0x1000, v8
    v_xor_b32 v13, 0x1000, v9
    v_xor_b32 v14, 0x1000, v10
    v_xor_b32 v15, 0x1000, v11
    v_bfe_u32 v6, v2, 2, 2
    v_lshl_add_u32 v7, v4, 3, v6
    v_lshlrev_b32 v7, 8, v7
    v_bfe_u32 v1, v2, 4, 1
    v_lshl_add_u32 v7, v1, 5, v7
    v_and_b32 v1, 3, v2
    v_lshl_add_u32 v7, v1, 3, v7
    v_add_u32 v7, 16384, v7
    s_lshl_b32 s30, s28, 1
    s_add_u32 s30, s30, s27
    s_xor_b32 s31, s30, 1
    v_xor_b32 v1, s30, v6
    v_lshl_add_u32 v16, v1, 6, v7
    v_xor_b32 v17, 64, v16
    v_lshrrev_b32 v1, 2, v2
    v_lshrrev_b32 v6, 4, v2
    v_xor_b32 v1, v1, v6
    v_and_b32 v1, 1, v1
    v_add_u32 v1, -1, v1
    v_and_b32 v18, 0x3f803f80, v1
    v_mov_b32 v19, v18
    v_mov_b32 v20, v18
    v_mov_b32 v21, v18
    s_getpc_b64 s[40:41]
L_block_kernel_pc_13:
    s_lshl_b32 s42, s26, 13
    v_lshl_add_u32 v6, v2, 7, s42
    v_min_u32 v6, code_end - L_block_kernel_pc_13 - 4, v6
    global_load_dword v200, v6, s[40:41]
    v_mov_b32 v22, 0
    v_mov_b32 v23, 0
    v_mov_b32 v24, 0
    v_mov_b32 v25, 0
    v_mov_b32 v80, 0
    v_mov_b32 v81, 0
    v_mov_b32 v82, 0
    v_mov_b32 v83, 0
    v_mov_b32 v84, 0
    v_mov_b32 v85, 0
    v_mov_b32 v86, 0
    v_mov_b32 v87, 0
    v_mov_b32 v88, 0
    v_mov_b32 v89, 0
    v_mov_b32 v90, 0
    v_mov_b32 v91, 0
    v_mov_b32 v92, 0
    v_mov_b32 v93, 0
    v_mov_b32 v94, 0
    v_mov_b32 v95, 0
    v_mov_b32 v96, 0
    v_mov_b32 v97, 0
    v_mov_b32 v98, 0
    v_mov_b32 v99, 0
    v_mov_b32 v100, 0
    v_mov_b32 v101, 0
    v_mov_b32 v102, 0
    v_mov_b32 v103, 0
    v_mov_b32 v104, 0
    v_mov_b32 v105, 0
    v_mov_b32 v106, 0
    v_mov_b32 v107, 0
    v_mov_b32 v108, 0
    v_mov_b32 v109, 0
    v_mov_b32 v110, 0
    v_mov_b32 v111, 0
    v_mov_b32 v112, 0
    v_mov_b32 v113, 0
    v_mov_b32 v114, 0
    v_mov_b32 v115, 0
    v_mov_b32 v116, 0
    v_mov_b32 v117, 0
    v_mov_b32 v118, 0
    v_mov_b32 v119, 0
    v_mov_b32 v120, 0
    v_mov_b32 v121, 0
    v_mov_b32 v122, 0
    v_mov_b32 v123, 0
    v_mov_b32 v124, 0
    v_mov_b32 v125, 0
    v_mov_b32 v126, 0
    v_mov_b32 v127, 0
    v_mov_b32 v128, 0
    v_mov_b32 v129, 0
    v_mov_b32 v130, 0
    v_mov_b32 v131, 0
    v_mov_b32 v132, 0
    v_mov_b32 v133, 0
    v_mov_b32 v134, 0
    v_mov_b32 v135, 0
    v_mov_b32 v136, 0
    v_mov_b32 v137, 0
    v_mov_b32 v138, 0
    v_mov_b32 v139, 0
    v_mov_b32 v140, 0
    v_mov_b32 v141, 0
    v_mov_b32 v142, 0
    v_mov_b32 v143, 0
    s_lshl1_add_u32 s32, s24, s27
    s_mul_i32 s32, s32, 5120
    s_add_u32 s33, s32, 2816
    s_cmp_ge_u32 s25, 10
    s_cbranch_scc1 L_block_kernel_v_14
    s_cmp_ge_u32 s25, 5
    s_cselect_b32 s35, 5, 0
    s_cselect_b32 s36, 0, 6291456
    s_cselect_b32 s37, 1.0, 0x3ea52b5c
    s_sub_u32 s29, s25, s35
    s_add_u32 s32, s32, s36
    v_lshlrev_b32 v1, 4, v3
    s_lshl2_add_u32 s35, s30, s29
    s_lshr_b32 s48, 0x421084, s35
    s_lshl2_add_u32 s35, s29, s30
    s_lshl_b32 s35, s35, 2
    s_mul_i32 s36, s35, 205
    s_lshr_b32 s36, s36, 10
    s_mul_i32 s36, s36, 325120
    s_lshl_b32 s33, s35, 9
    s_add_u32 s36, s36, s33
    s_bfe_u32 s33, s48, 0x20003
    s_cselect_b32 s33, 162304, 0
    s_add_u32 s36, s36, s33
    s_bitcmp1_b32 s48, 0
    s_cselect_b32 s33, 1280, 0
    s_cselect_b32 s43, 161024, 0
    s_add_u32 s36, s36, s33
    s_addk_i32 s43, 2816
    v_mad_u32_u24 v38, v4, s43, v1
    v_add_u32 v38, s36, v38
    s_add_u32 s35, s35, 1
    s_mul_i32 s36, s35, 205
    s_lshr_b32 s36, s36, 10
    s_mul_i32 s36, s36, 325120
    s_lshl_b32 s33, s35, 9
    s_add_u32 s36, s36, s33
    s_bfe_u32 s33, s48, 0x20004
    s_cselect_b32 s33, 162304, 0
    s_add_u32 s36, s36, s33
    s_bitcmp1_b32 s48, 1
    s_cselect_b32 s33, 1280, 0
    s_cselect_b32 s43, 161024, 0
    s_add_u32 s36, s36, s33
    s_addk_i32 s43, 2816
    v_mad_u32_u24 v39, v4, s43, v1
    v_add_u32 v39, s36, v39
    s_add_u32 s35, s35, 1
    s_mul_i32 s36, s35, 205
    s_lshr_b32 s36, s36, 10
    s_mul_i32 s36, s36, 325120
    s_lshl_b32 s33, s35, 9
    s_add_u32 s36, s36, s33
    s_bfe_u32 s33, s48, 0x20005
    s_cselect_b32 s33, 162304, 0
    s_add_u32 s36, s36, s33
    s_bitcmp1_b32 s48, 2
    s_cselect_b32 s33, 1280, 0
    s_cselect_b32 s43, 161024, 0
    s_add_u32 s36, s36, s33
    s_addk_i32 s43, 2816
    v_mad_u32_u24 v40, v4, s43, v1
    v_add_u32 v40, s36, v40
    s_add_u32 s35, s35, 1
    s_mul_i32 s36, s35, 205
    s_lshr_b32 s36, s36, 10
    s_mul_i32 s36, s36, 325120
    s_lshl_b32 s33, s35, 9
    s_add_u32 s36, s36, s33
    s_bfe_u32 s33, s48, 0x20006
    s_cselect_b32 s33, 162304, 0
    s_add_u32 s36, s36, s33
    s_bitcmp1_b32 s48, 3
    s_cselect_b32 s33, 1280, 0
    s_cselect_b32 s43, 161024, 0
    s_add_u32 s36, s36, s33
    s_addk_i32 s43, 2816
    v_mad_u32_u24 v41, v4, s43, v1
    v_add_u32 v41, s36, v41
    s_lshl2_add_u32 s35, s31, s29
    s_lshr_b32 s49, 0x421084, s35
    s_lshl2_add_u32 s35, s29, s31
    s_lshl_b32 s35, s35, 2
    s_mul_i32 s36, s35, 205
    s_lshr_b32 s36, s36, 10
    s_mul_i32 s36, s36, 325120
    s_lshl_b32 s33, s35, 9
    s_add_u32 s36, s36, s33
    s_bfe_u32 s33, s49, 0x20003
    s_cselect_b32 s33, 162304, 0
    s_add_u32 s36, s36, s33
    s_bitcmp1_b32 s49, 0
    s_cselect_b32 s33, 1280, 0
    s_cselect_b32 s43, 161024, 0
    s_add_u32 s36, s36, s33
    s_addk_i32 s43, 2816
    v_mad_u32_u24 v42, v4, s43, v1
    v_add_u32 v42, s36, v42
    s_add_u32 s35, s35, 1
    s_mul_i32 s36, s35, 205
    s_lshr_b32 s36, s36, 10
    s_mul_i32 s36, s36, 325120
    s_lshl_b32 s33, s35, 9
    s_add_u32 s36, s36, s33
    s_bfe_u32 s33, s49, 0x20004
    s_cselect_b32 s33, 162304, 0
    s_add_u32 s36, s36, s33
    s_bitcmp1_b32 s49, 1
    s_cselect_b32 s33, 1280, 0
    s_cselect_b32 s43, 161024, 0
    s_add_u32 s36, s36, s33
    s_addk_i32 s43, 2816
    v_mad_u32_u24 v43, v4, s43, v1
    v_add_u32 v43, s36, v43
    s_add_u32 s35, s35, 1
    s_mul_i32 s36, s35, 205
    s_lshr_b32 s36, s36, 10
    s_mul_i32 s36, s36, 325120
    s_lshl_b32 s33, s35, 9
    s_add_u32 s36, s36, s33
    s_bfe_u32 s33, s49, 0x20005
    s_cselect_b32 s33, 162304, 0
    s_add_u32 s36, s36, s33
    s_bitcmp1_b32 s49, 2
    s_cselect_b32 s33, 1280, 0
    s_cselect_b32 s43, 161024, 0
    s_add_u32 s36, s36, s33
    s_addk_i32 s43, 2816
    v_mad_u32_u24 v44, v4, s43, v1
    v_add_u32 v44, s36, v44
    s_add_u32 s35, s35, 1
    s_mul_i32 s36, s35, 205
    s_lshr_b32 s36, s36, 10
    s_mul_i32 s36, s36, 325120
    s_lshl_b32 s33, s35, 9
    s_add_u32 s36, s36, s33
    s_bfe_u32 s33, s49, 0x20006
    s_cselect_b32 s33, 162304, 0
    s_add_u32 s36, s36, s33
    s_bitcmp1_b32 s49, 3
    s_cselect_b32 s33, 1280, 0
    s_cselect_b32 s43, 161024, 0
    s_add_u32 s36, s36, s33
    s_addk_i32 s43, 2816
    v_mad_u32_u24 v45, v4, s43, v1
    v_add_u32 v45, s36, v45
    s_mov_b32 s34, 5
    s_lshl_b32 s35, s27, 8
    s_add_u32 s35, s35, 131072
    v_lshl_add_u32 v7, v3, 2, s35
    s_lshl_b32 s35, s30, 8
    s_add_u32 s35, s35, 132096
    v_lshl_add_u32 v1, v3, 3, s35
    v_xor_b32 v6, 256, v1
    v_add_u32 v4, -1, v4
    s_waitcnt lgkmcnt(0)
    s_barrier
    ds_read_b64_tr_b16 v[56:57], v16 offset:0
    ds_read_b64_tr_b16 v[58:59], v16 offset:1024
    ds_read_b128 v[48:51], v8 offset:0
    ds_read_b128 v[52:55], v12 offset:0
    ds_read_b64_tr_b16 v[60:61], v17 offset:0
    ds_read_b64_tr_b16 v[62:63], v17 offset:1024
    s_branch L_block_kernel_in_18
L_block_kernel_lpq_19:
L_block_kernel_loop_17:
    v_mfma_f32_32x32x16_bf16 v[112:127], v[72:75], v[68:71], v[112:127]
    ds_read_b128 v[52:55], v12 offset:0
    ds_read_b64_tr_b16 v[60:61], v17 offset:0
    ds_read_b64_tr_b16 v[62:63], v17 offset:1024
    v_mfma_f32_32x32x16_bf16 v[96:111], v[76:79], v[64:67], v[96:111]
    v_mfma_f32_32x32x16_bf16 v[128:143], v[76:79], v[68:71], v[128:143]
L_block_kernel_in_18:
    s_waitcnt lgkmcnt(3)
    v_mfma_f32_32x32x16_bf16 v[80:95], v[56:59], v[48:51], v[80:95]
    ds_read_b64_tr_b16 v[72:73], v16 offset:4096
    ds_read_b64_tr_b16 v[74:75], v16 offset:5120
    ds_read_b128 v[64:67], v9 offset:0
    v_mfma_f32_16x16x32_bf16 v[22:25], v[18:21], v[56:59], v[22:25]
    s_waitcnt lgkmcnt(3)
    v_mfma_f32_32x32x16_bf16 v[112:127], v[56:59], v[52:55], v[112:127]
    ds_read_b128 v[68:71], v13 offset:0
    ds_read_b64_tr_b16 v[76:77], v17 offset:4096
    ds_read_b64_tr_b16 v[78:79], v17 offset:5120
    v_mfma_f32_32x32x16_bf16 v[96:111], v[60:63], v[48:51], v[96:111]
    v_mfma_f32_32x32x16_bf16 v[128:143], v[60:63], v[52:55], v[128:143]
    s_waitcnt lgkmcnt(3)
    v_mfma_f32_32x32x16_bf16 v[80:95], v[72:75], v[64:67], v[80:95]
    ds_read_b64_tr_b16 v[56:57], v16 offset:8192
    ds_read_b64_tr_b16 v[58:59], v16 offset:9216
    ds_read_b128 v[48:51], v10 offset:0
    v_mfma_f32_16x16x32_bf16 v[22:25], v[18:21], v[72:75], v[22:25]
    s_waitcnt lgkmcnt(3)
    v_mfma_f32_32x32x16_bf16 v[112:127], v[72:75], v[68:71], v[112:127]
    ds_read_b128 v[52:55], v14 offset:0
    ds_read_b64_tr_b16 v[60:61], v17 offset:8192
    ds_read_b64_tr_b16 v[62:63], v17 offset:9216
    v_mfma_f32_32x32x16_bf16 v[96:111], v[76:79], v[64:67], v[96:111]
    v_mfma_f32_32x32x16_bf16 v[128:143], v[76:79], v[68:71], v[128:143]
    s_waitcnt lgkmcnt(3)
    v_mfma_f32_32x32x16_bf16 v[80:95], v[56:59], v[48:51], v[80:95]
    ds_read_b64_tr_b16 v[72:73], v16 offset:12288
    ds_read_b64_tr_b16 v[74:75], v16 offset:13312
    ds_read_b128 v[64:67], v11 offset:0
    v_mfma_f32_16x16x32_bf16 v[22:25], v[18:21], v[56:59], v[22:25]
    s_waitcnt lgkmcnt(3)
    v_mfma_f32_32x32x16_bf16 v[112:127], v[56:59], v[52:55], v[112:127]
    ds_read_b128 v[68:71], v15 offset:0
    ds_read_b64_tr_b16 v[76:77], v17 offset:12288
    ds_read_b64_tr_b16 v[78:79], v17 offset:13312
    v_mfma_f32_32x32x16_bf16 v[96:111], v[60:63], v[48:51], v[96:111]
    v_mfma_f32_32x32x16_bf16 v[128:143], v[60:63], v[52:55], v[128:143]
    s_waitcnt lgkmcnt(3)
    v_mfma_f32_32x32x16_bf16 v[80:95], v[72:75], v[64:67], v[80:95]
    s_waitcnt lgkmcnt(0)
    s_barrier
    ds_read_b64_tr_b16 v[56:57], v16 offset:32768
    ds_read_b64_tr_b16 v[58:59], v16 offset:33792
    ds_read_b128 v[48:51], v8 offset:32768
    v_mfma_f32_16x16x32_bf16 v[22:25], v[18:21], v[72:75], v[22:25]
    v_mfma_f32_32x32x16_bf16 v[112:127], v[72:75], v[68:71], v[112:127]
    ds_read_b128 v[52:55], v12 offset:32768
    ds_read_b64_tr_b16 v[60:61], v17 offset:32768
    ds_read_b64_tr_b16 v[62:63], v17 offset:33792
    v_mfma_f32_32x32x16_bf16 v[96:111], v[76:79], v[64:67], v[96:111]
    v_xor_b32 v8, 0x10000, v8
    v_xor_b32 v12, 0x10000, v12
    v_mfma_f32_32x32x16_bf16 v[128:143], v[76:79], v[68:71], v[128:143]
    s_waitcnt lgkmcnt(3)
    v_mfma_f32_32x32x16_bf16 v[80:95], v[56:59], v[48:51], v[80:95]
    ds_read_b64_tr_b16 v[72:73], v16 offset:36864
    ds_read_b64_tr_b16 v[74:75], v16 offset:37888
    ds_read_b128 v[64:67], v9 offset:32768
    v_mfma_f32_16x16x32_bf16 v[22:25], v[18:21], v[56:59], v[22:25]
    s_waitcnt lgkmcnt(3)
    v_mfma_f32_32x32x16_bf16 v[112:127], v[56:59], v[52:55], v[112:127]
    ds_read_b128 v[68:71], v13 offset:32768
    ds_read_b64_tr_b16 v[76:77], v17 offset:36864
    ds_read_b64_tr_b16 v[78:79], v17 offset:37888
    v_mfma_f32_32x32x16_bf16 v[96:111], v[60:63], v[48:51], v[96:111]
    v_xor_b32 v9, 0x10000, v9
    v_xor_b32 v13, 0x10000, v13
    v_mfma_f32_32x32x16_bf16 v[128:143], v[60:63], v[52:55], v[128:143]
    s_waitcnt lgkmcnt(3)
    v_mfma_f32_32x32x16_bf16 v[80:95], v[72:75], v[64:67], v[80:95]
    ds_read_b64_tr_b16 v[56:57], v16 offset:40960
    ds_read_b64_tr_b16 v[58:59], v16 offset:41984
    ds_read_b128 v[48:51], v10 offset:32768
    v_mfma_f32_16x16x32_bf16 v[22:25], v[18:21], v[72:75], v[22:25]
    s_waitcnt lgkmcnt(3)
    v_mfma_f32_32x32x16_bf16 v[112:127], v[72:75], v[68:71], v[112:127]
    ds_read_b128 v[52:55], v14 offset:32768
    ds_read_b64_tr_b16 v[60:61], v17 offset:40960
    ds_read_b64_tr_b16 v[62:63], v17 offset:41984
    v_mfma_f32_32x32x16_bf16 v[96:111], v[76:79], v[64:67], v[96:111]
    v_xor_b32 v10, 0x10000, v10
    v_xor_b32 v14, 0x10000, v14
    v_mfma_f32_32x32x16_bf16 v[128:143], v[76:79], v[68:71], v[128:143]
    s_waitcnt lgkmcnt(3)
    v_mfma_f32_32x32x16_bf16 v[80:95], v[56:59], v[48:51], v[80:95]
    ds_read_b64_tr_b16 v[72:73], v16 offset:45056
    ds_read_b64_tr_b16 v[74:75], v16 offset:46080
    ds_read_b128 v[64:67], v11 offset:32768
    v_mfma_f32_16x16x32_bf16 v[22:25], v[18:21], v[56:59], v[22:25]
    s_waitcnt lgkmcnt(3)
    v_mfma_f32_32x32x16_bf16 v[112:127], v[56:59], v[52:55], v[112:127]
    ds_read_b128 v[68:71], v15 offset:32768
    ds_read_b64_tr_b16 v[76:77], v17 offset:45056
    ds_read_b64_tr_b16 v[78:79], v17 offset:46080
    v_mfma_f32_32x32x16_bf16 v[96:111], v[60:63], v[48:51], v[96:111]
    v_xor_b32 v11, 0x10000, v11
    v_xor_b32 v15, 0x10000, v15
    v_xor_b32 v16, 0x10000, v16
    v_xor_b32 v17, 0x10000, v17
    s_sub_u32 s34, s34, 1
    s_cmp_lg_u32 s34, 0
    v_mfma_f32_32x32x16_bf16 v[128:143], v[60:63], v[52:55], v[128:143]
    s_waitcnt lgkmcnt(3)
    v_mfma_f32_32x32x16_bf16 v[80:95], v[72:75], v[64:67], v[80:95]
    s_waitcnt lgkmcnt(0)
    s_barrier
    ds_read_b64_tr_b16 v[56:57], v16 offset:0
    ds_read_b64_tr_b16 v[58:59], v16 offset:1024
    ds_read_b128 v[48:51], v8 offset:0
    v_mfma_f32_16x16x32_bf16 v[22:25], v[18:21], v[72:75], v[22:25]
    s_cbranch_scc1 L_block_kernel_loop_17
L_block_kernel_epq_20:
    ds_read2_b32 v[26:27], v7
    ds_read2_b32 v[28:29], v7 offset0:32 offset1:32
    s_setprio 2
    v_mfma_f32_32x32x16_bf16 v[112:127], v[72:75], v[68:71], v[112:127]
    ds_read_b32 v30, v7 offset:512
    ds_read_b32 v32, v7 offset:640
    s_nop 0
    v_cvt_pk_bf16_f32 v18, v22, v22
    v_and_b32 v20, 0xffff0000, v18
    v_sub_f32 v20, v22, v20
    v_cvt_pk_bf16_f32 v19, v20, v20
    ds_write_b64 v1, v[18:19]
    v_mfma_f32_32x32x16_bf16 v[96:111], v[76:79], v[64:67], v[96:111]
    v_and_b32 v34, v18, v4
    v_and_b32 v35, v19, v4
    s_waitcnt lgkmcnt(3)
    s_nop 0
    v_mfma_f32_32x32x8_bf16 v[80:95], v[34:35], v[26:27], v[80:95]
    v_mfma_f32_32x32x8_bf16 v[112:127], v[34:35], v[28:29], v[112:127]
    s_waitcnt lgkmcnt(0)
    s_barrier
    ds_read_b64 v[20:21], v6
    v_mfma_f32_32x32x16_bf16 v[128:143], v[76:79], v[68:71], v[128:143]
    v_mul_f32 v30, s37, v30
    v_mul_f32 v32, s37, v32
    s_nop 4
    v_pk_mul_f32 v[80:81], v[80:81], v[30:31] op_sel_hi:[1,0]
    v_pk_mul_f32 v[82:83], v[82:83], v[30:31] op_sel_hi:[1,0]
    v_pk_mul_f32 v[112:113], v[112:113], v[32:33] op_sel_hi:[1,0]
    v_pk_mul_f32 v[114:115], v[114:115], v[32:33] op_sel_hi:[1,0]
    s_bitcmp1_b32 s48, 0
    v_cvt_pk_bf16_f32 v80, v80, v81
    v_cvt_pk_bf16_f32 v81, v82, v83
    v_cvt_pk_bf16_f32 v82, v112, v113
    v_cvt_pk_bf16_f32 v83, v114, v115
    s_cbranch_scc1 L_block_kernel_mx_21
    v_permlane32_swap_b32 v80, v82
    v_permlane32_swap_b32 v81, v83
L_block_kernel_mx_21:
    buffer_store_dwordx4 v[80:83], v38, s[12:15], s32 offen sc1
    v_pk_mul_f32 v[84:85], v[84:85], v[30:31] op_sel_hi:[1,0]
    v_pk_mul_f32 v[86:87], v[86:87], v[30:31] op_sel_hi:[1,0]
    v_pk_mul_f32 v[116:117], v[116:117], v[32:33] op_sel_hi:[1,0]
    v_pk_mul_f32 v[118:119], v[118:119], v[32:33] op_sel_hi:[1,0]
    s_bitcmp1_b32 s48, 1
    v_cvt_pk_bf16_f32 v84, v84, v85
    v_cvt_pk_bf16_f32 v85, v86, v87
    v_cvt_pk_bf16_f32 v86, v116, v117
    v_cvt_pk_bf16_f32 v87, v118, v119
    s_cbranch_scc1 L_block_kernel_mx_22
    v_permlane32_swap_b32 v84, v86
    v_permlane32_swap_b32 v85, v87
L_block_kernel_mx_22:
    buffer_store_dwordx4 v[84:87], v39, s[12:15], s32 offen sc1
    s_waitcnt lgkmcnt(0)
    v_and_b32 v36, v20, v4
    v_and_b32 v37, v21, v4
    s_nop 1
    v_mfma_f32_32x32x8_bf16 v[96:111], v[36:37], v[26:27], v[96:111]
    v_mfma_f32_32x32x8_bf16 v[128:143], v[36:37], v[28:29], v[128:143]
    v_pk_mul_f32 v[88:89], v[88:89], v[30:31] op_sel_hi:[1,0]
    v_pk_mul_f32 v[90:91], v[90:91], v[30:31] op_sel_hi:[1,0]
    v_pk_mul_f32 v[120:121], v[120:121], v[32:33] op_sel_hi:[1,0]
    v_pk_mul_f32 v[122:123], v[122:123], v[32:33] op_sel_hi:[1,0]
    s_bitcmp1_b32 s48, 2
    v_cvt_pk_bf16_f32 v88, v88, v89
    v_cvt_pk_bf16_f32 v89, v90, v91
    v_cvt_pk_bf16_f32 v90, v120, v121
    v_cvt_pk_bf16_f32 v91, v122, v123
    s_cbranch_scc1 L_block_kernel_mx_23
    v_permlane32_swap_b32 v88, v90
    v_permlane32_swap_b32 v89, v91
L_block_kernel_mx_23:
    buffer_store_dwordx4 v[88:91], v40, s[12:15], s32 offen sc1
    v_pk_mul_f32 v[92:93], v[92:93], v[30:31] op_sel_hi:[1,0]
    v_pk_mul_f32 v[94:95], v[94:95], v[30:31] op_sel_hi:[1,0]
    v_pk_mul_f32 v[124:125], v[124:125], v[32:33] op_sel_hi:[1,0]
    v_pk_mul_f32 v[126:127], v[126:127], v[32:33] op_sel_hi:[1,0]
    s_bitcmp1_b32 s48, 3
    v_cvt_pk_bf16_f32 v92, v92, v93
    v_cvt_pk_bf16_f32 v93, v94, v95
    v_cvt_pk_bf16_f32 v94, v124, v125
    v_cvt_pk_bf16_f32 v95, v126, v127
    s_cbranch_scc1 L_block_kernel_mx_24
    v_permlane32_swap_b32 v92, v94
    v_permlane32_swap_b32 v93, v95
L_block_kernel_mx_24:
    buffer_store_dwordx4 v[92:95], v41, s[12:15], s32 offen sc1
    v_pk_mul_f32 v[96:97], v[96:97], v[30:31] op_sel_hi:[1,0]
    v_pk_mul_f32 v[98:99], v[98:99], v[30:31] op_sel_hi:[1,0]
    v_pk_mul_f32 v[128:129], v[128:129], v[32:33] op_sel_hi:[1,0]
    v_pk_mul_f32 v[130:131], v[130:131], v[32:33] op_sel_hi:[1,0]
    s_bitcmp1_b32 s49, 0
    v_cvt_pk_bf16_f32 v96, v96, v97
    v_cvt_pk_bf16_f32 v97, v98, v99
    v_cvt_pk_bf16_f32 v98, v128, v129
    v_cvt_pk_bf16_f32 v99, v130, v131
    s_cbranch_scc1 L_block_kernel_mx_25
    v_permlane32_swap_b32 v96, v98
    v_permlane32_swap_b32 v97, v99
L_block_kernel_mx_25:
    buffer_store_dwordx4 v[96:99], v42, s[12:15], s32 offen sc1
    v_pk_mul_f32 v[100:101], v[100:101], v[30:31] op_sel_hi:[1,0]
    v_pk_mul_f32 v[102:103], v[102:103], v[30:31] op_sel_hi:[1,0]
    v_pk_mul_f32 v[132:133], v[132:133], v[32:33] op_sel_hi:[1,0]
    v_pk_mul_f32 v[134:135], v[134:135], v[32:33] op_sel_hi:[1,0]
    s_bitcmp1_b32 s49, 1
    v_cvt_pk_bf16_f32 v100, v100, v101
    v_cvt_pk_bf16_f32 v101, v102, v103
    v_cvt_pk_bf16_f32 v102, v132, v133
    v_cvt_pk_bf16_f32 v103, v134, v135
    s_cbranch_scc1 L_block_kernel_mx_26
    v_permlane32_swap_b32 v100, v102
    v_permlane32_swap_b32 v101, v103
L_block_kernel_mx_26:
    buffer_store_dwordx4 v[100:103], v43, s[12:15], s32 offen sc1
    v_pk_mul_f32 v[104:105], v[104:105], v[30:31] op_sel_hi:[1,0]
    v_pk_mul_f32 v[106:107], v[106:107], v[30:31] op_sel_hi:[1,0]
    v_pk_mul_f32 v[136:137], v[136:137], v[32:33] op_sel_hi:[1,0]
    v_pk_mul_f32 v[138:139], v[138:139], v[32:33] op_sel_hi:[1,0]
    s_bitcmp1_b32 s49, 2
    v_cvt_pk_bf16_f32 v104, v104, v105
    v_cvt_pk_bf16_f32 v105, v106, v107
    v_cvt_pk_bf16_f32 v106, v136, v137
    v_cvt_pk_bf16_f32 v107, v138, v139
    s_cbranch_scc1 L_block_kernel_mx_27
    v_permlane32_swap_b32 v104, v106
    v_permlane32_swap_b32 v105, v107
L_block_kernel_mx_27:
    buffer_store_dwordx4 v[104:107], v44, s[12:15], s32 offen sc1
    v_pk_mul_f32 v[108:109], v[108:109], v[30:31] op_sel_hi:[1,0]
    v_pk_mul_f32 v[110:111], v[110:111], v[30:31] op_sel_hi:[1,0]
    v_pk_mul_f32 v[140:141], v[140:141], v[32:33] op_sel_hi:[1,0]
    v_pk_mul_f32 v[142:143], v[142:143], v[32:33] op_sel_hi:[1,0]
    s_bitcmp1_b32 s49, 3
    v_cvt_pk_bf16_f32 v108, v108, v109
    v_cvt_pk_bf16_f32 v109, v110, v111
    v_cvt_pk_bf16_f32 v110, v140, v141
    v_cvt_pk_bf16_f32 v111, v142, v143
    s_cbranch_scc1 L_block_kernel_mx_28
    v_permlane32_swap_b32 v108, v110
    v_permlane32_swap_b32 v109, v111
L_block_kernel_mx_28:
    buffer_store_dwordx4 v[108:111], v45, s[12:15], s32 offen sc1
    s_setprio 0
    s_branch L_block_kernel_k2s_1
L_block_kernel_v_14:
    s_sub_u32 s29, s25, 10
    s_lshl_b32 s29, s29, 7
    s_lshl_b32 s35, s30, 5
    s_add_u32 s35, s35, s29
    v_add_u32 v1, s35, v3
    v_mul_u32_u24 v6, 3277, v1
    v_lshrrev_b32 v6, 16, v6
    v_mul_u32_u24 v7, 20, v6
    v_sub_u32 v1, v1, v7
    v_mul_u32_u24 v6, 163840, v6
    v_lshl_add_u32 v6, v1, 4, v6
    v_mul_u32_u24 v1, 320, v4
    v_add_u32 v38, v6, v1
    s_lshl_b32 s35, s31, 5
    s_add_u32 s35, s35, s29
    v_add_u32 v1, s35, v3
    v_mul_u32_u24 v6, 3277, v1
    v_lshrrev_b32 v6, 16, v6
    v_mul_u32_u24 v7, 20, v6
    v_sub_u32 v1, v1, v7
    v_mul_u32_u24 v6, 163840, v6
    v_lshl_add_u32 v6, v1, 4, v6
    v_mul_u32_u24 v1, 320, v4
    v_add_u32 v39, v6, v1
    s_lshl_b32 s35, s27, 8
    s_add_u32 s35, s35, 131584
    v_lshl_add_u32 v40, v4, 4, s35
    v_xor_b32 v41, 128, v40
    s_mov_b32 s34, 5
    s_lshl_b32 s35, s27, 8
    s_add_u32 s35, s35, 131072
    v_lshl_add_u32 v7, v3, 2, s35
    s_lshl_b32 s35, s30, 8
    s_add_u32 s35, s35, 132096
    v_lshl_add_u32 v1, v3, 3, s35
    v_xor_b32 v6, 256, v1
    v_add_u32 v4, -1, v4
    s_waitcnt lgkmcnt(0)
    s_barrier
    ds_read_b64_tr_b16 v[56:57], v16 offset:0
    ds_read_b64_tr_b16 v[58:59], v16 offset:1024
    ds_read_b128 v[48:51], v8 offset:0
    ds_read_b128 v[52:55], v12 offset:0
    ds_read_b64_tr_b16 v[60:61], v17 offset:0
    ds_read_b64_tr_b16 v[62:63], v17 offset:1024
    s_branch L_block_kernel_in_30
L_block_kernel_lpv_31:
L_block_kernel_loop_29:
    v_mfma_f32_32x32x16_bf16 v[112:127], v[68:71], v[72:75], v[112:127]
    ds_read_b128 v[52:55], v12 offset:0
    ds_read_b64_tr_b16 v[60:61], v17 offset:0
    ds_read_b64_tr_b16 v[62:63], v17 offset:1024
    v_mfma_f32_32x32x16_bf16 v[96:111], v[64:67], v[76:79], v[96:111]
    v_mfma_f32_32x32x16_bf16 v[128:143], v[68:71], v[76:79], v[128:143]
L_block_kernel_in_30:
    s_waitcnt lgkmcnt(3)
    v_mfma_f32_32x32x16_bf16 v[80:95], v[48:51], v[56:59], v[80:95]
    ds_read_b64_tr_b16 v[72:73], v16 offset:4096
    ds_read_b64_tr_b16 v[74:75], v16 offset:5120
    ds_read_b128 v[64:67], v9 offset:0
    v_mfma_f32_16x16x32_bf16 v[22:25], v[18:21], v[56:59], v[22:25]
    s_waitcnt lgkmcnt(3)
    v_mfma_f32_32x32x16_bf16 v[112:127], v[52:55], v[56:59], v[112:127]
    ds_read_b128 v[68:71], v13 offset:0
    ds_read_b64_tr_b16 v[76:77], v17 offset:4096
    ds_read_b64_tr_b16 v[78:79], v17 offset:5120
    v_mfma_f32_32x32x16_bf16 v[96:111], v[48:51], v[60:63], v[96:111]
    v_mfma_f32_32x32x16_bf16 v[128:143], v[52:55], v[60:63], v[128:143]
    s_waitcnt lgkmcnt(3)
    v_mfma_f32_32x32x16_bf16 v[80:95], v[64:67], v[72:75], v[80:95]
    ds_read_b64_tr_b16 v[56:57], v16 offset:8192
    ds_read_b64_tr_b16 v[58:59], v16 offset:9216
    ds_read_b128 v[48:51], v10 offset:0
    v_mfma_f32_16x16x32_bf16 v[22:25], v[18:21], v[72:75], v[22:25]
    s_waitcnt lgkmcnt(3)
    v_mfma_f32_32x32x16_bf16 v[112:127], v[68:71], v[72:75], v[112:127]
    ds_read_b128 v[52:55], v14 offset:0
    ds_read_b64_tr_b16 v[60:61], v17 offset:8192
    ds_read_b64_tr_b16 v[62:63], v17 offset:9216
    v_mfma_f32_32x32x16_bf16 v[96:111], v[64:67], v[76:79], v[96:111]
    v_mfma_f32_32x32x16_bf16 v[128:143], v[68:71], v[76:79], v[128:143]
    s_waitcnt lgkmcnt(3)
    v_mfma_f32_32x32x16_bf16 v[80:95], v[48:51], v[56:59], v[80:95]
    ds_read_b64_tr_b16 v[72:73], v16 offset:12288
    ds_read_b64_tr_b16 v[74:75], v16 offset:13312
    ds_read_b128 v[64:67], v11 offset:0
    v_mfma_f32_16x16x32_bf16 v[22:25], v[18:21], v[56:59], v[22:25]
    s_waitcnt lgkmcnt(3)
    v_mfma_f32_32x32x16_bf16 v[112:127], v[52:55], v[56:59], v[112:127]
    ds_read_b128 v[68:71], v15 offset:0
    ds_read_b64_tr_b16 v[76:77], v17 offset:12288
    ds_read_b64_tr_b16 v[78:79], v17 offset:13312
    v_mfma_f32_32x32x16_bf16 v[96:111], v[48:51], v[60:63], v[96:111]
    v_mfma_f32_32x32x16_bf16 v[128:143], v[52:55], v[60:63], v[128:143]
    s_waitcnt lgkmcnt(3)
    v_mfma_f32_32x32x16_bf16 v[80:95], v[64:67], v[72:75], v[80:95]
    s_waitcnt lgkmcnt(0)
    s_barrier
    ds_read_b64_tr_b16 v[56:57], v16 offset:32768
    ds_read_b64_tr_b16 v[58:59], v16 offset:33792
    ds_read_b128 v[48:51], v8 offset:32768
    v_mfma_f32_16x16x32_bf16 v[22:25], v[18:21], v[72:75], v[22:25]
    v_mfma_f32_32x32x16_bf16 v[112:127], v[68:71], v[72:75], v[112:127]
    ds_read_b128 v[52:55], v12 offset:32768
    ds_read_b64_tr_b16 v[60:61], v17 offset:32768
    ds_read_b64_tr_b16 v[62:63], v17 offset:33792
    v_mfma_f32_32x32x16_bf16 v[96:111], v[64:67], v[76:79], v[96:111]
    v_xor_b32 v8, 0x10000, v8
    v_xor_b32 v12, 0x10000, v12
    v_mfma_f32_32x32x16_bf16 v[128:143], v[68:71], v[76:79], v[128:143]
    s_waitcnt lgkmcnt(3)
    v_mfma_f32_32x32x16_bf16 v[80:95], v[48:51], v[56:59], v[80:95]
    ds_read_b64_tr_b16 v[72:73], v16 offset:36864
    ds_read_b64_tr_b16 v[74:75], v16 offset:37888
    ds_read_b128 v[64:67], v9 offset:32768
    v_mfma_f32_16x16x32_bf16 v[22:25], v[18:21], v[56:59], v[22:25]
    s_waitcnt lgkmcnt(3)
    v_mfma_f32_32x32x16_bf16 v[112:127], v[52:55], v[56:59], v[112:127]
    ds_read_b128 v[68:71], v13 offset:32768
    ds_read_b64_tr_b16 v[76:77], v17 offset:36864
    ds_read_b64_tr_b16 v[78:79], v17 offset:37888
    v_mfma_f32_32x32x16_bf16 v[96:111], v[48:51], v[60:63], v[96:111]
    v_xor_b32 v9, 0x10000, v9
    v_xor_b32 v13, 0x10000, v13
    v_mfma_f32_32x32x16_bf16 v[128:143], v[52:55], v[60:63], v[128:143]
    s_waitcnt lgkmcnt(3)
    v_mfma_f32_32x32x16_bf16 v[80:95], v[64:67], v[72:75], v[80:95]
    ds_read_b64_tr_b16 v[56:57], v16 offset:40960
    ds_read_b64_tr_b16 v[58:59], v16 offset:41984
    ds_read_b128 v[48:51], v10 offset:32768
    v_mfma_f32_16x16x32_bf16 v[22:25], v[18:21], v[72:75], v[22:25]
    s_waitcnt lgkmcnt(3)
    v_mfma_f32_32x32x16_bf16 v[112:127], v[68:71], v[72:75], v[112:127]
    ds_read_b128 v[52:55], v14 offset:32768
    ds_read_b64_tr_b16 v[60:61], v17 offset:40960
    ds_read_b64_tr_b16 v[62:63], v17 offset:41984
    v_mfma_f32_32x32x16_bf16 v[96:111], v[64:67], v[76:79], v[96:111]
    v_xor_b32 v10, 0x10000, v10
    v_xor_b32 v14, 0x10000, v14
    v_mfma_f32_32x32x16_bf16 v[128:143], v[68:71], v[76:79], v[128:143]
    s_waitcnt lgkmcnt(3)
    v_mfma_f32_32x32x16_bf16 v[80:95], v[48:51], v[56:59], v[80:95]
    ds_read_b64_tr_b16 v[72:73], v16 offset:45056
    ds_read_b64_tr_b16 v[74:75], v16 offset:46080
    ds_read_b128 v[64:67], v11 offset:32768
    v_mfma_f32_16x16x32_bf16 v[22:25], v[18:21], v[56:59], v[22:25]
    s_waitcnt lgkmcnt(3)
    v_mfma_f32_32x32x16_bf16 v[112:127], v[52:55], v[56:59], v[112:127]
    ds_read_b128 v[68:71], v15 offset:32768
    ds_read_b64_tr_b16 v[76:77], v17 offset:45056
    ds_read_b64_tr_b16 v[78:79], v17 offset:46080
    v_mfma_f32_32x32x16_bf16 v[96:111], v[48:51], v[60:63], v[96:111]
    v_xor_b32 v11, 0x10000, v11
    v_xor_b32 v15, 0x10000, v15
    v_xor_b32 v16, 0x10000, v16
    v_xor_b32 v17, 0x10000, v17
    s_sub_u32 s34, s34, 1
    s_cmp_lg_u32 s34, 0
    v_mfma_f32_32x32x16_bf16 v[128:143], v[52:55], v[60:63], v[128:143]
    s_waitcnt lgkmcnt(3)
    v_mfma_f32_32x32x16_bf16 v[80:95], v[64:67], v[72:75], v[80:95]
    s_waitcnt lgkmcnt(0)
    s_barrier
    ds_read_b64_tr_b16 v[56:57], v16 offset:0
    ds_read_b64_tr_b16 v[58:59], v16 offset:1024
    ds_read_b128 v[48:51], v8 offset:0
    v_mfma_f32_16x16x32_bf16 v[22:25], v[18:21], v[72:75], v[22:25]
    s_cbranch_scc1 L_block_kernel_loop_29
L_block_kernel_epv_32:
    ds_read2_b32 v[26:27], v7
    ds_read2_b32 v[28:29], v7 offset0:32 offset1:32
    s_setprio 2
    v_mfma_f32_32x32x16_bf16 v[112:127], v[68:71], v[72:75], v[112:127]
    ds_read_b128 v[168:171], v40 offset:0
    ds_read_b128 v[172:175], v40 offset:32
    ds_read_b128 v[176:179], v40 offset:64
    ds_read_b128 v[180:183], v40 offset:96
    ds_read_b128 v[144:147], v41 offset:0
    ds_read_b128 v[148:151], v41 offset:32
    ds_read_b128 v[152:155], v41 offset:64
    ds_read_b128 v[156:159], v41 offset:96
    v_cvt_pk_bf16_f32 v18, v22, v22
    v_and_b32 v20, 0xffff0000, v18
    v_sub_f32 v20, v22, v20
    v_cvt_pk_bf16_f32 v19, v20, v20
    ds_write_b64 v1, v[18:19]
    v_mfma_f32_32x32x16_bf16 v[96:111], v[64:67], v[76:79], v[96:111]
    v_and_b32 v34, v18, v4
    v_and_b32 v35, v19, v4
    s_waitcnt lgkmcnt(9)
    s_nop 0
    v_mfma_f32_32x32x8_bf16 v[80:95], v[26:27], v[34:35], v[80:95]
    v_mfma_f32_32x32x8_bf16 v[112:127], v[28:29], v[34:35], v[112:127]
    s_waitcnt lgkmcnt(0)
    s_barrier
    ds_read_b64 v[20:21], v6
    v_mfma_f32_32x32x16_bf16 v[128:143], v[68:71], v[76:79], v[128:143]
    s_nop 6
    v_pk_mul_f32 v[80:81], v[80:81], v[168:169]
    v_pk_mul_f32 v[82:83], v[82:83], v[170:171]
    v_pk_mul_f32 v[84:85], v[84:85], v[172:173]
    v_pk_mul_f32 v[86:87], v[86:87], v[174:175]
    v_cvt_pk_bf16_f32 v80, v80, v81
    v_cvt_pk_bf16_f32 v81, v82, v83
    v_cvt_pk_bf16_f32 v82, v84, v85
    v_cvt_pk_bf16_f32 v83, v86, v87
    buffer_store_dwordx4 v[80:83], v38, s[12:15], s32 offen offset:1024 sc1
    v_pk_mul_f32 v[88:89], v[88:89], v[176:177]
    v_pk_mul_f32 v[90:91], v[90:91], v[178:179]
    v_pk_mul_f32 v[92:93], v[92:93], v[180:181]
    v_pk_mul_f32 v[94:95], v[94:95], v[182:183]
    v_cvt_pk_bf16_f32 v88, v88, v89
    v_cvt_pk_bf16_f32 v89, v90, v91
    v_cvt_pk_bf16_f32 v90, v92, v93
    v_cvt_pk_bf16_f32 v91, v94, v95
    buffer_store_dwordx4 v[88:91], v38, s[12:15], s32 offen offset:1664 sc1
    s_waitcnt lgkmcnt(0)
    v_and_b32 v36, v20, v4
    v_and_b32 v37, v21, v4
    s_nop 1
    v_mfma_f32_32x32x8_bf16 v[96:111], v[26:27], v[36:37], v[96:111]
    v_mfma_f32_32x32x8_bf16 v[128:143], v[28:29], v[36:37], v[128:143]
    v_pk_mul_f32 v[112:113], v[112:113], v[144:145]
    v_pk_mul_f32 v[114:115], v[114:115], v[146:147]
    v_pk_mul_f32 v[116:117], v[116:117], v[148:149]
    v_pk_mul_f32 v[118:119], v[118:119], v[150:151]
    v_cvt_pk_bf16_f32 v112, v112, v113
    v_cvt_pk_bf16_f32 v113, v114, v115
    v_cvt_pk_bf16_f32 v114, v116, v117
    v_cvt_pk_bf16_f32 v115, v118, v119
    buffer_store_dwordx4 v[112:115], v38, s[12:15], s33 offen offset:1024 sc1
    v_pk_mul_f32 v[120:121], v[120:121], v[152:153]
    v_pk_mul_f32 v[122:123], v[122:123], v[154:155]
    v_pk_mul_f32 v[124:125], v[124:125], v[156:157]
    v_pk_mul_f32 v[126:127], v[126:127], v[158:159]
    v_cvt_pk_bf16_f32 v120, v120, v121
    v_cvt_pk_bf16_f32 v121, v122, v123
    v_cvt_pk_bf16_f32 v122, v124, v125
    v_cvt_pk_bf16_f32 v123, v126, v127
    buffer_store_dwordx4 v[120:123], v38, s[12:15], s33 offen offset:1664 sc1
    v_pk_mul_f32 v[96:97], v[96:97], v[168:169]
    v_pk_mul_f32 v[98:99], v[98:99], v[170:171]
    v_pk_mul_f32 v[100:101], v[100:101], v[172:173]
    v_pk_mul_f32 v[102:103], v[102:103], v[174:175]
    v_cvt_pk_bf16_f32 v96, v96, v97
    v_cvt_pk_bf16_f32 v97, v98, v99
    v_cvt_pk_bf16_f32 v98, v100, v101
    v_cvt_pk_bf16_f32 v99, v102, v103
    buffer_store_dwordx4 v[96:99], v39, s[12:15], s32 offen offset:1024 sc1
    v_pk_mul_f32 v[104:105], v[104:105], v[176:177]
    v_pk_mul_f32 v[106:107], v[106:107], v[178:179]
    v_pk_mul_f32 v[108:109], v[108:109], v[180:181]
    v_pk_mul_f32 v[110:111], v[110:111], v[182:183]
    v_cvt_pk_bf16_f32 v104, v104, v105
    v_cvt_pk_bf16_f32 v105, v106, v107
    v_cvt_pk_bf16_f32 v106, v108, v109
    v_cvt_pk_bf16_f32 v107, v110, v111
    buffer_store_dwordx4 v[104:107], v39, s[12:15], s32 offen offset:1664 sc1
    v_pk_mul_f32 v[128:129], v[128:129], v[144:145]
    v_pk_mul_f32 v[130:131], v[130:131], v[146:147]
    v_pk_mul_f32 v[132:133], v[132:133], v[148:149]
    v_pk_mul_f32 v[134:135], v[134:135], v[150:151]
    v_cvt_pk_bf16_f32 v128, v128, v129
    v_cvt_pk_bf16_f32 v129, v130, v131
    v_cvt_pk_bf16_f32 v130, v132, v133
    v_cvt_pk_bf16_f32 v131, v134, v135
    buffer_store_dwordx4 v[128:131], v39, s[12:15], s33 offen offset:1024 sc1
    v_pk_mul_f32 v[136:137], v[136:137], v[152:153]
    v_pk_mul_f32 v[138:139], v[138:139], v[154:155]
    v_pk_mul_f32 v[140:141], v[140:141], v[156:157]
    v_pk_mul_f32 v[142:143], v[142:143], v[158:159]
    v_cvt_pk_bf16_f32 v136, v136, v137
    v_cvt_pk_bf16_f32 v137, v138, v139
    v_cvt_pk_bf16_f32 v138, v140, v141
    v_cvt_pk_bf16_f32 v139, v142, v143
    buffer_store_dwordx4 v[136:139], v39, s[12:15], s33 offen offset:1664 sc1
    s_setprio 0
    s_branch L_block_kernel_k2s_1
L_block_kernel_help_5:
    s_waitcnt vmcnt(16)
    v_cmp_gt_u32 vcc, 16, v3
    s_lshl2_add_u32 s30, s24, s26
    s_cbranch_vccz L_block_kernel_clr_34
    s_movk_i32 s48, 20000
    s_mov_b64 exec, 1
L_block_kernel_poll_37:
    v_mov_b32 v3, 0
    buffer_atomic_or v3, off, s[20:23], 0 sc0 sc1
L_block_kernel_pc_39:
    s_sub_u32 s48, s48, 1
    s_cselect_b64 s[50:51], 0, -1
    s_waitcnt vmcnt(0)
    v_cmp_gt_u32 vcc, 16, v3
    s_and_b64 s[50:51], s[50:51], vcc
    s_cbranch_scc1 L_block_kernel_poll_37
    s_mov_b64 exec, -1
L_block_kernel_po_38:
L_block_kernel_clr_34:
    s_lshl_b32 s30, s30, 8
    s_add_u32 s30, s30, 38535168
    v_lshlrev_b32 v1, 3, v2
    s_mov_b64 exec, 0xffffffff
    buffer_load_dwordx2 v[4:5], v1, s[12:15], s30 offen sc0 sc1
    s_lshl_b32 s31, s26, 7
    s_add_u32 s31, s31, 131072
    v_lshl_add_u32 v6, v2, 2, s31
    s_movk_i32 s48, 20000
    s_waitcnt vmcnt(9)
    s_barrier
    s_waitcnt vmcnt(1)
    s_barrier
    s_branch L_block_kernel_xc_36
L_block_kernel_xs_35:
    v_mov_b32 v4, 0
    v_mov_b32 v5, 0
    buffer_atomic_or_x2 v[4:5], v1, s[12:15], s30 offen sc0 sc1
L_block_kernel_xc_36:
    s_sub_u32 s48, s48, 1
    s_cselect_b64 s[50:51], 0, -1
    s_waitcnt vmcnt(0)
    v_lshrrev_b32 v7, 16, v4
    v_and_b32 v7, v7, v5
    v_and_b32 v7, 1, v7
    v_cmp_eq_u32 vcc, 0, v7
    s_and_b64 s[50:51], s[50:51], vcc
    s_cbranch_scc1 L_block_kernel_xs_35
    ds_write2_b32 v6, v4, v5 offset1:128
    s_mov_b64 exec, -1
    s_waitcnt lgkmcnt(0)
    s_barrier
    s_barrier
L_block_kernel_warm_33:
    s_mov_b64 exec, 0
    s_cmp_eq_u32 s26, 0
    s_cbranch_scc1 H_block_kernel_seg0
    s_cmp_eq_u32 s26, 1
    s_cbranch_scc1 H_block_kernel_seg1
    s_cmp_eq_u32 s26, 2
    s_cbranch_scc1 H_block_kernel_seg2
    s_branch H_block_kernel_seg3
L_block_kernel_spare_2:
    s_and_b32 s24, s38, 1
    s_lshl1_add_u32 s24, s40, s24
    s_lshl2_add_u32 s24, s39, s24
    s_lshl3_add_u32 s27, s24, s26
    s_lshl_b32 s29, s27, 7
    s_add_u32 s29, s29, 38535168
    s_mul_i32 s27, s27, 20480
    s_add_u32 s28, s27, 10240
    v_lshrrev_b32 v1, 3, v2
    v_and_b32 v5, 7, v2
    v_mul_u32_u24 v10, 1280, v1
    v_lshl_add_u32 v10, v5, 4, v10
    v_lshl_add_u32 v11, v5, 3, v1
    v_lshlrev_b32 v11, 3, v11
    v_mov_b32 v12, 0
    v_mov_b32 v13, 0
    v_mov_b32 v14, 0
    v_mov_b32 v15, 0
    s_mov_b32 s32, 0x3f803f80
    s_cmp_lg_u32 s26, 0
    s_waitcnt lgkmcnt(0)
    s_cbranch_scc1 L_block_kernel_nc_40
    s_sub_u32 s38, s2, 240
    s_lshl_b32 s30, s38, 14
    s_add_u32 s30, s30, 37748736
    v_lshlrev_b32 v8, 8, v2
    v_mov_b32 v4, 1
    buffer_store_dword v12, v8, s[12:15], s30 offen sc1
    s_lshl_b32 s30, s38, 15
    s_add_u32 s30, s30, 38010880
    s_add_u32 s31, s30, 16384
    v_lshlrev_b32 v9, 8, v2
    v_lshlrev_b32 v6, 4, v2
    buffer_store_dwordx2 v[12:13], v9, s[12:15], s30 offen sc1
    buffer_store_dwordx2 v[12:13], v9, s[12:15], s31 offen sc1
    buffer_store_dwordx4 v[12:15], v6, s[12:15], s29 offen sc1
    s_waitcnt vmcnt(0)
    buffer_atomic_add v4, v8, s[20:23], 0 offen sc1
L_block_kernel_nc_40:
    s_barrier
    buffer_load_dwordx4 v[16:19], v10, s[4:7], s27 offen offset:512
    buffer_load_dwordx4 v[20:23], v10, s[4:7], s28 offen offset:512
    buffer_load_dwordx4 v[24:27], v10, s[4:7], s27 offen offset:1152
    buffer_load_dwordx4 v[28:31], v10, s[4:7], s28 offen offset:1152
    s_barrier
    buffer_load_dwordx4 v[32:35], v10, s[4:7], s27 offen offset:0
    buffer_load_dwordx4 v[36:39], v10, s[4:7], s28 offen offset:0
    buffer_load_dwordx4 v[40:43], v10, s[4:7], s27 offen offset:640
    buffer_load_dwordx4 v[44:47], v10, s[4:7], s28 offen offset:640
    buffer_load_dwordx4 v[48:51], v10, s[4:7], s27 offen offset:256
    buffer_load_dwordx4 v[52:55], v10, s[4:7], s28 offen offset:256
    buffer_load_dwordx4 v[56:59], v10, s[4:7], s27 offen offset:896
    buffer_load_dwordx4 v[60:63], v10, s[4:7], s28 offen offset:896
    buffer_load_dwordx4 v[64:67], v10, s[4:7], s27 offen offset:128
    buffer_load_dwordx4 v[68:71], v10, s[4:7], s28 offen offset:128
    buffer_load_dwordx4 v[72:75], v10, s[4:7], s27 offen offset:768
    buffer_load_dwordx4 v[76:79], v10, s[4:7], s28 offen offset:768
    buffer_load_dwordx4 v[80:83], v10, s[4:7], s27 offen offset:384
    buffer_load_dwordx4 v[84:87], v10, s[4:7], s28 offen offset:384
    buffer_load_dwordx4 v[88:91], v10, s[4:7], s27 offen offset:1024
    buffer_load_dwordx4 v[92:95], v10, s[4:7], s28 offen offset:1024
    s_waitcnt vmcnt(18)
    v_dot2c_f32_bf16 v12, s32, v16
    v_dot2c_f32_bf16 v14, v16, v16
    v_dot2c_f32_bf16 v13, s32, v20
    v_dot2c_f32_bf16 v15, v20, v20
    v_dot2c_f32_bf16 v12, s32, v17
    v_dot2c_f32_bf16 v14, v17, v17
    v_dot2c_f32_bf16 v13, s32, v21
    v_dot2c_f32_bf16 v15, v21, v21
    v_dot2c_f32_bf16 v12, s32, v18
    v_dot2c_f32_bf16 v14, v18, v18
    v_dot2c_f32_bf16 v13, s32, v22
    v_dot2c_f32_bf16 v15, v22, v22
    v_dot2c_f32_bf16 v12, s32, v19
    v_dot2c_f32_bf16 v14, v19, v19
    v_dot2c_f32_bf16 v13, s32, v23
    v_dot2c_f32_bf16 v15, v23, v23
    s_waitcnt vmcnt(16)
    v_dot2c_f32_bf16 v12, s32, v24
    v_dot2c_f32_bf16 v14, v24, v24
    v_dot2c_f32_bf16 v13, s32, v28
    v_dot2c_f32_bf16 v15, v28, v28
    v_dot2c_f32_bf16 v12, s32, v25
    v_dot2c_f32_bf16 v14, v25, v25
    v_dot2c_f32_bf16 v13, s32, v29
    v_dot2c_f32_bf16 v15, v29, v29
    v_dot2c_f32_bf16 v12, s32, v26
    v_dot2c_f32_bf16 v14, v26, v26
    v_dot2c_f32_bf16 v13, s32, v30
    v_dot2c_f32_bf16 v15, v30, v30
    v_dot2c_f32_bf16 v12, s32, v27
    v_dot2c_f32_bf16 v14, v27, v27
    v_dot2c_f32_bf16 v13, s32, v31
    v_dot2c_f32_bf16 v15, v31, v31
    s_waitcnt vmcnt(14)
    v_dot2c_f32_bf16 v12, s32, v32
    v_dot2c_f32_bf16 v14, v32, v32
    v_dot2c_f32_bf16 v13, s32, v36
    v_dot2c_f32_bf16 v15, v36, v36
    v_dot2c_f32_bf16 v12, s32, v33
    v_dot2c_f32_bf16 v14, v33, v33
    v_dot2c_f32_bf16 v13, s32, v37
    v_dot2c_f32_bf16 v15, v37, v37
    v_dot2c_f32_bf16 v12, s32, v34
    v_dot2c_f32_bf16 v14, v34, v34
    v_dot2c_f32_bf16 v13, s32, v38
    v_dot2c_f32_bf16 v15, v38, v38
    v_dot2c_f32_bf16 v12, s32, v35
    v_dot2c_f32_bf16 v14, v35, v35
    v_dot2c_f32_bf16 v13, s32, v39
    v_dot2c_f32_bf16 v15, v39, v39
    s_waitcnt vmcnt(12)
    v_dot2c_f32_bf16 v12, s32, v40
    v_dot2c_f32_bf16 v14, v40, v40
    v_dot2c_f32_bf16 v13, s32, v44
    v_dot2c_f32_bf16 v15, v44, v44
    v_dot2c_f32_bf16 v12, s32, v41
    v_dot2c_f32_bf16 v14, v41, v41
    v_dot2c_f32_bf16 v13, s32, v45
    v_dot2c_f32_bf16 v15, v45, v45
    v_dot2c_f32_bf16 v12, s32, v42
    v_dot2c_f32_bf16 v14, v42, v42
    v_dot2c_f32_bf16 v13, s32, v46
    v_dot2c_f32_bf16 v15, v46, v46
    v_dot2c_f32_bf16 v12, s32, v43
    v_dot2c_f32_bf16 v14, v43, v43
    v_dot2c_f32_bf16 v13, s32, v47
    v_dot2c_f32_bf16 v15, v47, v47
    s_waitcnt vmcnt(10)
    v_dot2c_f32_bf16 v12, s32, v48
    v_dot2c_f32_bf16 v14, v48, v48
    v_dot2c_f32_bf16 v13, s32, v52
    v_dot2c_f32_bf16 v15, v52, v52
    v_dot2c_f32_bf16 v12, s32, v49
    v_dot2c_f32_bf16 v14, v49, v49
    v_dot2c_f32_bf16 v13, s32, v53
    v_dot2c_f32_bf16 v15, v53, v53
    v_dot2c_f32_bf16 v12, s32, v50
    v_dot2c_f32_bf16 v14, v50, v50
    v_dot2c_f32_bf16 v13, s32, v54
    v_dot2c_f32_bf16 v15, v54, v54
    v_dot2c_f32_bf16 v12, s32, v51
    v_dot2c_f32_bf16 v14, v51, v51
    v_dot2c_f32_bf16 v13, s32, v55
    v_dot2c_f32_bf16 v15, v55, v55
    s_waitcnt vmcnt(8)
    v_dot2c_f32_bf16 v12, s32, v56
    v_dot2c_f32_bf16 v14, v56, v56
    v_dot2c_f32_bf16 v13, s32, v60
    v_dot2c_f32_bf16 v15, v60, v60
    v_dot2c_f32_bf16 v12, s32, v57
    v_dot2c_f32_bf16 v14, v57, v57
    v_dot2c_f32_bf16 v13, s32, v61
    v_dot2c_f32_bf16 v15, v61, v61
    v_dot2c_f32_bf16 v12, s32, v58
    v_dot2c_f32_bf16 v14, v58, v58
    v_dot2c_f32_bf16 v13, s32, v62
    v_dot2c_f32_bf16 v15, v62, v62
    v_dot2c_f32_bf16 v12, s32, v59
    v_dot2c_f32_bf16 v14, v59, v59
    v_dot2c_f32_bf16 v13, s32, v63
    v_dot2c_f32_bf16 v15, v63, v63
    s_waitcnt vmcnt(6)
    v_dot2c_f32_bf16 v12, s32, v64
    v_dot2c_f32_bf16 v14, v64, v64
    v_dot2c_f32_bf16 v13, s32, v68
    v_dot2c_f32_bf16 v15, v68, v68
    v_dot2c_f32_bf16 v12, s32, v65
    v_dot2c_f32_bf16 v14, v65, v65
    v_dot2c_f32_bf16 v13, s32, v69
    v_dot2c_f32_bf16 v15, v69, v69
    v_dot2c_f32_bf16 v12, s32, v66
    v_dot2c_f32_bf16 v14, v66, v66
    v_dot2c_f32_bf16 v13, s32, v70
    v_dot2c_f32_bf16 v15, v70, v70
    v_dot2c_f32_bf16 v12, s32, v67
    v_dot2c_f32_bf16 v14, v67, v67
    v_dot2c_f32_bf16 v13, s32, v71
    v_dot2c_f32_bf16 v15, v71, v71
    s_waitcnt vmcnt(4)
    v_dot2c_f32_bf16 v12, s32, v72
    v_dot2c_f32_bf16 v14, v72, v72
    v_dot2c_f32_bf16 v13, s32, v76
    v_dot2c_f32_bf16 v15, v76, v76
    v_dot2c_f32_bf16 v12, s32, v73
    v_dot2c_f32_bf16 v14, v73, v73
    v_dot2c_f32_bf16 v13, s32, v77
    v_dot2c_f32_bf16 v15, v77, v77
    v_dot2c_f32_bf16 v12, s32, v74
    v_dot2c_f32_bf16 v14, v74, v74
    v_dot2c_f32_bf16 v13, s32, v78
    v_dot2c_f32_bf16 v15, v78, v78
    v_dot2c_f32_bf16 v12, s32, v75
    v_dot2c_f32_bf16 v14, v75, v75
    v_dot2c_f32_bf16 v13, s32, v79
    v_dot2c_f32_bf16 v15, v79, v79
    s_waitcnt vmcnt(2)
    v_dot2c_f32_bf16 v12, s32, v80
    v_dot2c_f32_bf16 v14, v80, v80
    v_dot2c_f32_bf16 v13, s32, v84
    v_dot2c_f32_bf16 v15, v84, v84
    v_dot2c_f32_bf16 v12, s32, v81
    v_dot2c_f32_bf16 v14, v81, v81
    v_dot2c_f32_bf16 v13, s32, v85
    v_dot2c_f32_bf16 v15, v85, v85
    v_dot2c_f32_bf16 v12, s32, v82
    v_dot2c_f32_bf16 v14, v82, v82
    v_dot2c_f32_bf16 v13, s32, v86
    v_dot2c_f32_bf16 v15, v86, v86
    v_dot2c_f32_bf16 v12, s32, v83
    v_dot2c_f32_bf16 v14, v83, v83
    v_dot2c_f32_bf16 v13, s32, v87
    v_dot2c_f32_bf16 v15, v87, v87
    s_waitcnt vmcnt(0)
    v_dot2c_f32_bf16 v12, s32, v88
    v_dot2c_f32_bf16 v14, v88, v88
    v_dot2c_f32_bf16 v13, s32, v92
    v_dot2c_f32_bf16 v15, v92, v92
    v_dot2c_f32_bf16 v12, s32, v89
    v_dot2c_f32_bf16 v14, v89, v89
    v_dot2c_f32_bf16 v13, s32, v93
    v_dot2c_f32_bf16 v15, v93, v93
    v_dot2c_f32_bf16 v12, s32, v90
    v_dot2c_f32_bf16 v14, v90, v90
    v_dot2c_f32_bf16 v13, s32, v94
    v_dot2c_f32_bf16 v15, v94, v94
    v_dot2c_f32_bf16 v12, s32, v91
    v_dot2c_f32_bf16 v14, v91, v91
    v_dot2c_f32_bf16 v13, s32, v95
    v_dot2c_f32_bf16 v15, v95, v95
    v_add_f32_dpp v12, v12, v12 quad_perm:[1,0,3,2] row_mask:0xf bank_mask:0xf
    s_nop 0
    v_add_f32_dpp v13, v13, v13 quad_perm:[1,0,3,2] row_mask:0xf bank_mask:0xf
    v_add_f32_dpp v14, v14, v14 quad_perm:[1,0,3,2] row_mask:0xf bank_mask:0xf
    v_add_f32_dpp v15, v15, v15 quad_perm:[1,0,3,2] row_mask:0xf bank_mask:0xf
    v_add_f32_dpp v12, v12, v12 quad_perm:[2,3,0,1] row_mask:0xf bank_mask:0xf
    v_add_f32_dpp v13, v13, v13 quad_perm:[2,3,0,1] row_mask:0xf bank_mask:0xf
    v_add_f32_dpp v14, v14, v14 quad_perm:[2,3,0,1] row_mask:0xf bank_mask:0xf
    v_add_f32_dpp v15, v15, v15 quad_perm:[2,3,0,1] row_mask:0xf bank_mask:0xf
    v_add_f32_dpp v12, v12, v12 row_half_mirror row_mask:0xf bank_mask:0xf
    v_add_f32_dpp v13, v13, v13 row_half_mirror row_mask:0xf bank_mask:0xf
    v_add_f32_dpp v14, v14, v14 row_half_mirror row_mask:0xf bank_mask:0xf
    v_add_f32_dpp v15, v15, v15 row_half_mirror row_mask:0xf bank_mask:0xf
    v_cmp_eq_u32 vcc, 1, v5
    s_nop 1
    v_cndmask_b32 v12, v12, v13, vcc
    v_cndmask_b32 v14, v14, v15, vcc
    v_mul_f32 v12, 0xbacccccd, v12
    v_mul_f32 v14, 0x3acccccd, v14
    v_fma_f32 v14, -v12, v12, v14
    v_cvt_pk_bf16_f32 v13, v12, v12
    v_max_f32 v14, 0, v14
    v_and_b32 v13, 0xffff0000, v13
    v_add_f32 v14, 0x3727c5ac, v14
    v_sub_f32 v13, v12, v13
    v_rsq_f32 v14, v14
    v_cvt_pk_bf16_f32 v12, v12, v13
    v_cmp_gt_u32 vcc, 2, v5
    v_or_b32 v12, 0x10000, v12
    v_or_b32 v13, 1, v14
    s_mov_b64 exec, vcc
    buffer_store_dwordx2 v[12:13], v11, s[12:15], s29 offen sc1
    s_mov_b64 exec, -1
    s_cmp_lg_u32 s26, 0
    s_cselect_b32 s27, 3, 0
    s_and_b32 s26, s26, 3
    s_cmp_lg_u32 s27, 0
    s_cbranch_scc1 L_block_kernel_warm_33
    s_movk_i32 s48, 20000
    s_mov_b64 exec, 1
L_block_kernel_poll_41:
    v_mov_b32 v3, 0
    buffer_atomic_or v3, off, s[20:23], 0 sc0 sc1
L_block_kernel_pc_43:
    s_sub_u32 s48, s48, 1
    s_cselect_b64 s[50:51], 0, -1
    s_waitcnt vmcnt(0)
    v_cmp_gt_u32 vcc, 16, v3
    s_nop 0
    s_and_b64 s[50:51], s[50:51], vcc
    s_cbranch_scc1 L_block_kernel_poll_41
    s_mov_b64 exec, -1
L_block_kernel_po_42:
    s_branch L_block_kernel_warm_33
H_block_kernel_seg0:
H_block_kernel_0:
    s_cbranch_execz H_block_kernel_1
L_block_kernel_k2s_1:
H_block_kernel_end:
    s_mov_b64 exec, -1
    v_lshrrev_b32 v1, 6, v0
    v_and_b32 v2, 63, v0
    v_readfirstlane_b32 s30, v1
    s_and_b32 s28, s2, 7
    s_lshl_b32 s28, s28, 2
H_block_kernel_1:
    s_cbranch_execz H_block_kernel_2
    s_lshr_b32 s29, s2, 6
    s_add_u32 s28, s28, s29
    v_lshlrev_b32 v21, 4, v2
    s_mul_i32 s31, s28, 163840
    s_lshl_b32 s34, s30, 11
    s_add_u32 s35, s31, s34
    s_mov_b32 m0, s34
    v_and_b32 v3, 31, v2
    v_lshrrev_b32 v4, 5, v2
    s_bfe_u32 s29, s2, 0x30003
    s_lshr_b32 s39, s30, 2
    s_lshl_b32 s32, s29, 2
    s_and_b32 s33, s30, 3
    s_add_u32 s32, s32, s33
    s_lshl_b32 s32, s32, 1
    s_mul_i32 s33, s32, 2560
    s_add_u32 s33, s33, s31
    s_add_u32 s33, s33, 6291456
    s_add_u32 s32, s32, s39
    s_mul_i32 s37, s39, 2816
    s_add_u32 s36, s33, s37
    s_sub_u32 s38, s33, s37
    v_lshlrev_b32 v5, 4, v3
    v_xor_b32 v1, s39, v4
    v_lshl_add_u32 v1, v1, 3, v5
    v_lshrrev_b32 v6, 1, v2
    v_xor_b32 v6, v6, v2
    v_and_b32 v6, 4, v6
    v_mul_u32_u24 v6, 48, v6
    v_xad_u32 v18, v21, v6, s37
    v_add_u32 v5, 2304, v5
    s_lshl_b32 s40, s39, 3
    v_xad_u32 v19, v5, v6, s40
    v_mov_b32 v246, 0xdddddddd
    v_mul_u32_u24 v20, 320, v4
    v_lshl_add_u32 v20, v3, 4, v20
    s_add_u32 s37, s37, 1024
    v_add_u32 v20, s37, v20
    s_mov_b32 s50, 0x000fffff
    s_mov_b32 s51, 0x000fffff
    v_mov_b32 v136, 0
    v_mov_b32 v137, 0
    v_mov_b32 v138, 0
    v_mov_b32 v139, 0
    v_mov_b32 v140, 0
    v_mov_b32 v141, 0
    v_mov_b32 v142, 0
    v_mov_b32 v143, 0
H_block_kernel_2:
    s_cbranch_execz H_block_kernel_3
    v_mov_b32 v144, 0
    v_mov_b32 v145, 0
    v_mov_b32 v146, 0
    v_mov_b32 v147, 0
    v_mov_b32 v148, 0
    v_mov_b32 v149, 0
    v_mov_b32 v150, 0
    v_mov_b32 v151, 0
    v_mov_b32 v152, 0
    v_mov_b32 v153, 0
    v_mov_b32 v154, 0
    v_mov_b32 v155, 0
    v_mov_b32 v156, 0
    v_mov_b32 v157, 0
    v_mov_b32 v158, 0
    v_mov_b32 v159, 0
    v_mov_b32 v160, 0
    v_mov_b32 v161, 0
    v_mov_b32 v162, 0
    v_mov_b32 v163, 0
    v_mov_b32 v164, 0
    v_mov_b32 v165, 0
    v_mov_b32 v166, 0
    v_mov_b32 v167, 0
    v_cmp_eq_u32 vcc, 20, v3
    v_mov_b32 v6, 0x3f803f80
    s_nop 0
    v_cndmask_b32 v180, 0, v6, vcc
    v_cndmask_b32 v181, 0, v6, vcc
    v_cndmask_b32 v182, 0, v6, vcc
    v_cndmask_b32 v183, 0, v6, vcc
    v_cndmask_b32 v184, 0, v6, vcc
    v_cndmask_b32 v185, 0, v6, vcc
    v_cndmask_b32 v186, 0, v6, vcc
    v_cndmask_b32 v187, 0, v6, vcc
    v_cndmask_b32 v188, 0, v6, vcc
    v_cndmask_b32 v189, 0, v6, vcc
    v_cndmask_b32 v190, 0, v6, vcc
    v_cndmask_b32 v191, 0, v6, vcc
    v_cndmask_b32 v192, 0, v6, vcc
    v_cndmask_b32 v193, 0, v6, vcc
    v_cndmask_b32 v194, 0, v6, vcc
    v_cndmask_b32 v195, 0, v6, vcc
    s_and_b32 s40, s2, 1
    s_lshl_b32 s40, s40, 2
    s_lshr_b32 s41, s2, 6
    s_add_u32 s40, s40, s41
    s_lshl_b32 s41, s40, 1
    s_bfe_u32 s42, s2, 0x10003
    s_add_u32 s41, s41, s42
    s_add_u32 s40, s40, 8
    v_lshl_add_u32 v227, v2, 3, s40
    v_writelane_b32 v227, s41, 0
    v_lshlrev_b32 v227, 8, v227
    v_mov_b32 v228, 48
    v_writelane_b32 v228, 20, 1
    v_mov_b32 v226, 0
    s_mov_b32 s48, 37953536
H_block_kernel_3:
    s_cbranch_execz H_block_kernel_end
    s_cmp_eq_u32 s30, 4
    s_cselect_b32 s49, 1, -2
    v_mov_b32 v229, 1
    v_lshrrev_b32 v6, 3, v0
    v_lshlrev_b32 v6, 18, v6
    s_cmp_ge_u32 s2, 240
    s_cselect_b32 s40, 0x800000, 0
    v_or3_b32 v6, v6, v0, s40
    v_lshlrev_b32 v6, 8, v6
    s_lshl_b32 s40, s25, 11
    s_add_u32 s40, s40, 37961728
    s_mul_i32 s41, s28, 20
    s_add_u32 s42, s41, 19
    s_lshr_b32 s41, s41, 7
    s_lshr_b32 s42, s42, 7
    s_sub_u32 s42, s42, s41
    s_cmp_eq_u32 s42, 0
    s_cselect_b64 s[46:47], 21, 63
    v_and_b32 v7, s42, v2
    v_lshrrev_b32 v24, 1, v2
    v_mad_u32_u24 v7, v24, 5, v7
    v_lshlrev_b32 v7, 11, v7
    s_lshl3_add_u32 s41, s41, s29
    s_lshl_b32 s41, s41, 8
    s_add_u32 s41, s41, 37961728
    s_load_dwordx4 s[24:27], s[0:1], 32
    s_load_dwordx2 s[16:17], s[0:1], 48
    s_load_dwordx2 s[22:23], s[0:1], 16
    s_mov_b32 s18, 1966080
    s_mov_b32 s19, 0x00020000
    s_waitcnt vmcnt(0)
    s_barrier
    buffer_atomic_add v229, v6, s[12:15], s40 offen sc1
    s_mov_b64 exec, 0
    s_cmp_eq_u32 s30, 1
    s_cbranch_scc1 Hb_block_kernel_end
    s_cmp_eq_u32 s30, 0
    s_cbranch_scc1 Hb_block_kernel_seg0
    s_cmp_eq_u32 s30, 2
    s_cbranch_scc1 Hb_block_kernel_seg2
    s_cmp_eq_u32 s30, 3
    s_cbranch_scc1 Hb_block_kernel_seg3
    s_cmp_eq_u32 s30, 4
    s_cbranch_scc1 Hb_block_kernel_seg4
    s_cmp_eq_u32 s30, 5
    s_cbranch_scc1 Hb_block_kernel_seg5
    s_cmp_eq_u32 s30, 6
    s_cbranch_scc1 Hb_block_kernel_seg6
    s_branch Hb_block_kernel_seg7
Hb_block_kernel_end:
    s_mov_b64 exec, -1
H_block_kernel_seg1:
H_block_kernel_4:
    s_cbranch_execz H_block_kernel_5
    v_mov_b32 v120, -1
    v_mov_b32 v121, -1
    v_mov_b32 v122, -1
    v_mov_b32 v123, -1
    s_bfe_u32 s54, s2, 0x20001
    s_bfe_u32 s55, s2, 0x30003
    s_lshl3_add_u32 s54, s54, s55
    s_and_b32 s55, s30, 3
    s_lshl2_add_u32 s54, s54, s55
    s_and_b32 s55, s2, 1
    s_lshr_b32 s56, s2, 6
    s_lshl2_add_u32 s55, s55, s56
    s_mul_i32 s56, s54, 20480
    s_mul_i32 s57, s55, 2560
    s_add_u32 s56, s56, s57
    s_add_u32 s56, s56, 16777216
    s_lshl_b32 s55, s55, 14
    s_lshl_b32 s54, s54, 7
    s_add_u32 s54, s54, s55
    s_add_u32 s54, s54, 19922944
    s_lshr_b32 s55, s30, 2
    s_lshl_b32 s55, s55, 10
    s_add_u32 s55, s55, s56
    s_cmp_lg_u32 s30, 1
    s_cbranch_scc1 L_block_kernel_po_45
    s_mov_b64 exec, s[46:47]
    v_mov_b32 v88, 0
    buffer_atomic_or v88, v7, s[12:15], s41 offen sc0 sc1
    s_movk_i32 s44, 20
L_block_kernel_pd_47:
    s_sub_u32 s44, s44, 1
    s_cbranch_scc0 L_block_kernel_pd_47
    s_movk_i32 s44, 20000
L_block_kernel_poll_44:
    v_mov_b32 v89, 0
    buffer_atomic_or v89, v7, s[12:15], s41 offen sc0 sc1
    s_waitcnt vmcnt(1)
    v_cmp_gt_u32 vcc, 16, v88
    s_cbranch_vccz L_block_kernel_pc_46
    v_mov_b32 v88, 0
    buffer_atomic_or v88, v7, s[12:15], s41 offen sc0 sc1
    s_waitcnt vmcnt(1)
    v_cmp_gt_u32 vcc, 16, v89
    s_cbranch_vccz L_block_kernel_pc_46
    s_sub_u32 s44, s44, 1
    s_cbranch_scc0 L_block_kernel_poll_44
L_block_kernel_pc_46:
    s_mov_b64 exec, -1
L_block_kernel_po_45:
    s_barrier
    buffer_load_dwordx4 v21, s[12:15], s35 offen offset:0 sc1 lds
    buffer_load_dwordx4 v21, s[12:15], s35 offen offset:1024 sc1 lds
    s_lshl_b32 s3, s30, 10
    s_add_u32 m0, s3, 147456
    buffer_load_dwordx2 v[16:17], v1, s[12:15], s33 offen offset:2304 sc1
H_block_kernel_5:
    s_cbranch_execz H_block_kernel_6
    buffer_load_dwordx4 v21, s[12:15], s36 offen sc1 lds
    v_add_u32 v22, m0, v21
    v_xor_b32 v128, 4096, v22
    v_bfrev_b32 v230, 1
    v_bfrev_b32 v232, 1
    v_bfrev_b32 v233, 1
    s_mov_b32 s47, -4
    s_mov_b32 s46, 0
    s_mul_i32 s9, s30, 5120
    v_and_b32 v6, 3, v2
    v_bfe_u32 v7, v2, 4, 1
    v_bfe_u32 v1, v2, 2, 2
    v_mov_b32 v216, v21
    v_mov_b32 v217, v21
    s_lshl3_add_u32 s3, s2, s30
    s_sub_u32 s3, s3, 1536
    s_waitcnt lgkmcnt(0)
    s_cbranch_scc0 L_block_kernel_j2_49
    s_cmp_ge_u32 s30, 4
    s_cbranch_scc1 L_block_kernel_j13_48
    s_lshl2_add_u32 s3, s2, s30
    s_add_u32 s3, s3, 512
    s_cmp_lt_u32 s2, 8
    s_cbranch_scc0 L_block_kernel_jn_53
L_block_kernel_j2_49:
    s_mul_i32 s40, s3, 5120
    s_cmp_lt_u32 s3, 160
    s_cbranch_scc1 L_block_kernel_jwo_50
    s_add_u32 s40, s40, 29589504
    s_sub_u32 s3, s3, 160
    s_mul_i32 s10, s3, 1366
    s_lshr_b32 s10, s10, 16
    s_mul_i32 s11, s10, 48
    s_sub_u32 s11, s3, s11
    s_add_u32 s52, s10, 24
    s_and_b32 s3, s11, 15
    s_mul_i32 s3, s3, 96
    s_and_b32 s11, s11, 48
    s_add_u32 s11, s11, s3
    s_mov_b32 s3, 48
    s_mov_b32 s20, 8
    s_mov_b32 s21, 4
    s_branch L_block_kernel_jgo_51
L_block_kernel_jwo_50:
    s_add_u32 s40, s40, 29360128
    s_mul_i32 s10, s3, 3277
    s_lshr_b32 s10, s10, 16
    s_mul_i32 s11, s10, 20
    s_sub_u32 s11, s3, s11
H_block_kernel_6:
    s_cbranch_execz H_block_kernel_7
    s_mov_b64 s[16:17], s[22:23]
    s_mov_b32 s18, 819200
    s_add_u32 s52, s10, 16
    s_mul_i32 s3, s11, 40
    s_mul_i32 s20, s11, 160
    s_sub_u32 s20, s20, 2544
    s_cmp_ge_u32 s11, 16
    s_cselect_b32 s11, s20, s3
    s_cselect_b32 s3, 80, 20
    s_cselect_b32 s20, 40, 4
    s_cselect_b32 s21, 20, 8
L_block_kernel_jgo_51:
    s_mul_i32 s11, s11, 1280
    s_mul_i32 s10, s10, 160
    s_add_u32 s4, s11, s10
    s_mul_i32 s10, s3, 1280
    s_add_u32 s5, s4, s10
    s_add_u32 s6, s4, 64
    s_add_u32 s7, s5, 64
    s_add_u32 s8, s4, 128
    v_mad_u32_u24 v232, s20, v4, v1
    v_mad_u32_u24 v232, s21, v7, v232
    v_mul_u32_u24 v232, 1280, v232
    v_lshl_add_u32 v232, v6, 4, v232
    v_bfe_u32 v233, v2, 1, 2
    v_mad_u32_u24 v233, s20, v7, v233
    v_mad_u32_u24 v233, s3, v4, v233
    v_bfe_u32 v7, v2, 3, 1
    v_mad_u32_u24 v233, s21, v7, v233
    v_mul_u32_u24 v233, 1280, v233
    v_and_b32 v7, 1, v2
    v_lshl_add_u32 v233, v7, 4, v233
    v_lshrrev_b32 v7, 4, v2
    v_lshl_add_u32 v1, v7, 3, v1
    v_lshlrev_b32 v1, 5, v1
    v_lshl_add_u32 v7, v6, 3, v1
    v_lshl_add_u32 v234, v7, 1, s9
    v_add_u32 v235, 8, v234
    v_add_u32 v236, 2048, v234
    v_add_u32 v237, 2056, v234
H_block_kernel_7:
    s_cbranch_execz H_block_kernel_end
    v_add_u32 v7, 4096, v7
    v_add_u32 v238, s9, v7
    v_add_u32 v239, 128, v238
    s_movk_i32 s10, 1024
    s_movk_i32 s11, 1024
    s_branch L_block_kernel_jd_52
L_block_kernel_j13_48:
    s_lshr_b32 s3, s2, 1
    s_and_b32 s20, s2, 1
    s_lshl2_add_u32 s20, s20, s30
    s_sub_u32 s20, s20, 4
    s_mul_i32 s52, s3, 171
    s_lshr_b32 s52, s52, 10
    s_mul_i32 s10, s52, 6
    s_sub_u32 s3, s3, s10
    s_bitcmp1_b32 s3, 0
    s_cselect_b32 s16, s26, s24
    s_cselect_b32 s17, s27, s25
    s_mov_b32 s18, 1966080
    s_lshr_b32 s10, s3, 1
    s_lshl1_add_u32 s3, s10, s3
    s_lshl_b32 s10, s10, 6
    s_mul_i32 s11, s52, 192
    s_add_u32 s10, s10, s11
    s_mul_i32 s11, s20, 245760
    s_add_u32 s4, s10, s11
    s_add_u32 s5, s4, 49152
    s_add_u32 s6, s4, 98304
    s_add_u32 s7, s4, 147456
    s_add_u32 s8, s4, 196608
    s_mul_i32 s45, s52, 251904
    s_add_u32 s45, s45, 33554432
    s_lshl_b32 s3, s3, 9
    s_add_u32 s45, s45, s3
    s_add_u32 s40, s45, s3
    s_mul_i32 s3, s20, 5
    s_lshr_b32 s10, s3, 1
    s_mul_i32 s10, s10, 12288
    s_add_u32 s40, s40, s10
    s_and_b32 s3, s3, 1
    s_cselect_b32 s10, 11776-512, 0
    s_add_u32 s10, s10, 512
    s_xor_b32 s11, s10, 11264
    s_lshl_b32 s3, s3, 9
    s_add_u32 s40, s40, s3
    s_add_u32 s40, s40, 6144
    s_lshr_b32 s3, s20, 2
H_block_kernel_seg2:
H_block_kernel_8:
    s_cbranch_execz H_block_kernel_9
    s_lshl_b32 s3, s3, 8
    s_and_b32 s20, s20, 3
    s_lshl2_add_u32 s3, s20, s3
    s_add_u32 s45, s45, s3
    s_mov_b32 s46, 1
    v_lshl_add_u32 v1, v4, 3, v1
    v_lshl_add_u32 v1, v1, 6, s9
    v_lshl_add_u32 v1, v7, 5, v1
    v_lshl_add_u32 v234, v6, 3, v1
    v_add_u32 v235, 1024, v234
    v_add_u32 v236, 2048, v234
    v_add_u32 v237, 3072, v234
    v_add_u32 v238, 4096, v234
    v_add_u32 v239, 4352, v234
    v_lshrrev_b32 v1, 2, v2
    v_mul_u32_u24 v232, 3072, v1
    v_lshl_add_u32 v232, v6, 4, v232
    v_mov_b32 v233, v232
    v_xor_b32 v1, v1, v7
    v_and_b32 v1, 1, v1
    v_add_u32 v1, -1, v1
    v_and_b32 v218, 0x3f803f80, v1
    v_mov_b32 v219, v218
    v_mov_b32 v220, v218
    v_mov_b32 v221, v218
    v_and_b32 v1, 15, v2
    v_lshlrev_b32 v1, 4, v1
    v_lshl_add_u32 v216, v4, 8, v1
    v_lshl_add_u32 v216, v7, 11, v216
    v_lshl_add_u32 v217, v7, 10, v1
L_block_kernel_jd_52:
    s_add_u32 s41, s40, s10
    s_add_u32 s42, s41, s11
    s_add_u32 s43, s42, s10
    s_add_u32 s44, s43, s11
    s_lshl_b32 s52, s52, 8
    v_lshl_or_b32 v230, v2, 26, s52
    s_mov_b32 s47, 1
L_block_kernel_jn_53:
    s_sub_u32 s47, s47, s39
    s_add_u32 s39, s49, 1
    s_add_u32 s23, s47, 1
    s_sub_u32 s53, s47, 1
    s_lshl2_add_u32 s3, s30, 40960
    v_and_b32 v6, 3, v2
    v_bfe_u32 v7, v2, 1, 1
    v_lshl_add_u32 v6, v6, 1, v7
H_block_kernel_9:
    s_cbranch_execz H_block_kernel_10
    v_lshl_add_u32 v240, v6, 9, s3
    v_mov_b32 v241, 0xffff0000
    s_and_b32 s3, s30, 3
    s_mul_i32 s3, s3, 3072
    s_add_u32 s3, s3, 61440
    v_add_u32 v242, s3, v21
    s_mov_b32 s22, s30
    s_mul_i32 s3, s32, 40960
    s_add_u32 s3, s3, 12582912
    s_lshl_b32 s24, s28, 9
    s_add_u32 s24, s24, s3
    s_lshr_b32 s25, s28, 2
    s_and_b32 s10, s28, 1
    s_lshl1_add_u32 s25, s25, s10
    s_bfe_u32 s10, s28, 0x10001
    s_lshl1_add_u32 s25, s25, s10
    s_lshl_b32 s25, s25, 7
    s_add_u32 s25, s25, s3
    s_add_u32 s25, s25, 16384
    s_sub_u32 s26, s24, 40960
    s_sub_u32 s27, s25, 40960
    v_lshrrev_b32 v1, 4, v3
    v_mul_u32_u24 v1, 20480, v1
    v_and_b32 v7, 15, v3
    v_lshl_add_u32 v244, v7, 4, v1
    v_lshl_add_u32 v245, v7, 3, v1
    v_lshl_add_u32 v244, v4, 8, v244
    s_waitcnt vmcnt(0)
    s_add_u32 m0, s34, 16384
    s_add_u32 s35, s35, 16384
    buffer_load_dwordx4 v21, s[12:15], s35 offen offset:0 sc1 lds
    buffer_load_dwordx4 v21, s[12:15], s35 offen offset:1024 sc1 lds
    s_add_u32 m0, s34, 32768
    s_add_u32 s35, s35, 16384
    buffer_load_dwordx4 v21, s[12:15], s35 offen offset:0 sc1 lds
    buffer_load_dwordx4 v21, s[12:15], s35 offen offset:1024 sc1 lds
    s_barrier
    ds_read_b128 v[8:11], v22
    ds_read_b128 v[12:15], v128
H_block_kernel_10:
    s_cbranch_execz H_block_kernel_11
    ds_read_b64 v[124:125], v5
    ds_read_b128 v[120:123], v21
    ds_read_b128 v[168:171], v18 offset:0
    ds_read_b64 v[176:177], v19 offset:0
    ds_read_b128 v[172:175], v18 offset:5120
    ds_read_b64 v[178:179], v19 offset:5120
    s_mov_b64 exec, s[50:51]
    ds_read_b128 v[180:183], v20 offset:0
    ds_read_b128 v[184:187], v20 offset:640
    s_mov_b64 exec, -1
    s_waitcnt lgkmcnt(6)
    v_mfma_f32_32x32x16_bf16 v[88:103], v[120:123], v[8:11], 0
    v_mfma_f32_32x32x16_bf16 v[104:119], v[120:123], v[12:15], 0
    s_nop 11
    v_mfma_f32_32x32x4_2b_bf16 v[88:119], v[124:125], v[16:17], v[88:119]
    s_nop 15
    s_nop 3
    v_max3_f32 v6, v88, v89, v90
    v_max_f32 v6, v6, v91
    v_max3_f32 v6, v6, v92, v93
    v_max3_f32 v6, v6, v94, v95
    v_max3_f32 v6, v6, v96, v97
    v_max3_f32 v6, v6, v98, v99
    v_max3_f32 v6, v6, v100, v101
    v_max3_f32 v6, v6, v102, v103
    v_max3_f32 v7, v104, v105, v106
    v_max_f32 v7, v7, v107
    v_max3_f32 v7, v7, v108, v109
    v_max3_f32 v7, v7, v110, v111
    v_max3_f32 v7, v7, v112, v113
    v_max3_f32 v7, v7, v114, v115
    v_max3_f32 v7, v7, v116, v117
    v_max3_f32 v7, v7, v118, v119
    s_nop 1
    v_permlane32_swap_b32 v6, v7
    v_max_f32 v6, v6, v7
    v_mov_b32 v7, v6
H_block_kernel_11:
    s_cbranch_execz H_block_kernel_12
    s_nop 1
    v_permlane32_swap_b32 v6, v7
    v_sub_f32 v24, 0, v6
    v_sub_f32 v25, 0, v6
    v_sub_f32 v26, 0, v6
    v_sub_f32 v27, 0, v6
    v_sub_f32 v28, 0, v6
    v_sub_f32 v29, 0, v6
    v_sub_f32 v30, 0, v6
    v_sub_f32 v31, 0, v6
    v_sub_f32 v32, 0, v6
    v_sub_f32 v33, 0, v6
    v_sub_f32 v34, 0, v6
    v_sub_f32 v35, 0, v6
    v_sub_f32 v36, 0, v6
    v_sub_f32 v37, 0, v6
    v_sub_f32 v38, 0, v6
    v_sub_f32 v39, 0, v6
    v_sub_f32 v40, 0, v7
    v_sub_f32 v41, 0, v7
    v_sub_f32 v42, 0, v7
    v_sub_f32 v43, 0, v7
    v_sub_f32 v44, 0, v7
    v_sub_f32 v45, 0, v7
    v_sub_f32 v46, 0, v7
    v_sub_f32 v47, 0, v7
    v_sub_f32 v48, 0, v7
    v_sub_f32 v49, 0, v7
    v_sub_f32 v50, 0, v7
    v_sub_f32 v51, 0, v7
    v_sub_f32 v52, 0, v7
    v_sub_f32 v53, 0, v7
    v_sub_f32 v54, 0, v7
    v_sub_f32 v55, 0, v7
    s_waitcnt lgkmcnt(4)
    v_mfma_f32_32x32x16_bf16 v[56:71], v[168:171], v[8:11], v[24:39]
    v_mfma_f32_32x32x16_bf16 v[72:87], v[168:171], v[12:15], v[40:55]
    s_nop 11
    v_mfma_f32_32x32x4_2b_bf16 v[56:87], v[176:177], v[16:17], v[56:87]
    s_mov_b32 s36, 0
    s_mov_b32 s38, 0
L_block_kernel_main_61:
    s_nop 15
    s_nop 1
    v_exp_f32 v56, v56
    v_exp_f32 v57, v57
    s_waitcnt lgkmcnt(0)
    s_mov_b64 exec, s[50:51]
    ds_read_b128 v[188:191], v20 offset:5120
    ds_read_b128 v[192:195], v20 offset:5760
    s_mov_b64 exec, -1
    ds_read_b128 v[168:171], v18 offset:10240
    ds_read_b64 v[176:177], v19 offset:10240
    v_exp_f32 v58, v58
    v_exp_f32 v59, v59
    v_exp_f32 v60, v60
    v_mfma_f32_32x32x4_2b_bf16 v[88:119], v[178:179], v[16:17], v[24:55]
H_block_kernel_12:
    s_cbranch_execz H_block_kernel_end
    v_exp_f32 v61, v61
    v_exp_f32 v62, v62
    v_exp_f32 v63, v63
    v_exp_f32 v64, v64
    v_exp_f32 v65, v65
    v_exp_f32 v66, v66
    v_exp_f32 v67, v67
    v_exp_f32 v68, v68
    v_smfmac_f32_32x32x32_bf16 v[136:151], v[180:183], v[56:63], v246
    v_exp_f32 v69, v69
    v_exp_f32 v70, v70
    v_exp_f32 v71, v71
    v_exp_f32 v72, v72
    s_nop 6
    v_mfma_f32_32x32x16_bf16 v[88:103], v[172:175], v[8:11], v[88:103]
    v_exp_f32 v73, v73
    v_exp_f32 v74, v74
    v_exp_f32 v75, v75
    v_exp_f32 v76, v76
    v_smfmac_f32_32x32x32_bf16 v[136:151], v[184:187], v[64:71], v246
    s_add_u32 m0, s34, 49152
    s_add_u32 s35, s35, 16384
    buffer_load_dwordx4 v21, s[12:15], s35 offen offset:0 sc1 lds
    buffer_load_dwordx4 v21, s[12:15], s35 offen offset:1024 sc1 lds
    v_exp_f32 v77, v77
    v_exp_f32 v78, v78
    v_exp_f32 v79, v79
    v_exp_f32 v80, v80
    v_mfma_f32_32x32x16_bf16 v[104:119], v[172:175], v[12:15], v[104:119]
    v_exp_f32 v81, v81
    v_exp_f32 v82, v82
    v_exp_f32 v83, v83
    v_exp_f32 v84, v84
    v_smfmac_f32_32x32x32_bf16 v[152:167], v[180:183], v[72:79], v246
    v_exp_f32 v85, v85
    v_exp_f32 v86, v86
    v_exp_f32 v87, v87
    v_exp_f32 v88, v88
    v_exp_f32 v89, v89
    v_smfmac_f32_32x32x32_bf16 v[152:167], v[184:187], v[80:87], v246
    s_waitcnt vmcnt(4)
    s_barrier
    s_waitcnt lgkmcnt(0)
    s_mov_b64 exec, s[50:51]
    ds_read_b128 v[180:183], v20 offset:10240
    ds_read_b128 v[184:187], v20 offset:10880
    s_mov_b64 exec, -1
    ds_read_b128 v[172:175], v18 offset:15360
    ds_read_b64 v[178:179], v19 offset:15360
    v_exp_f32 v90, v90
    v_exp_f32 v91, v91
    v_exp_f32 v92, v92
    v_mfma_f32_32x32x4_2b_bf16 v[56:87], v[176:177], v[16:17], v[24:55]
    v_exp_f32 v93, v93
    v_exp_f32 v94, v94
    v_exp_f32 v95, v95
    v_exp_f32 v96, v96
    v_exp_f32 v97, v97
    v_exp_f32 v98, v98
    v_exp_f32 v99, v99
    v_exp_f32 v100, v100
    v_smfmac_f32_32x32x32_bf16 v[136:151], v[188:191], v[88:95], v246
    v_exp_f32 v101, v101
    v_exp_f32 v102, v102
    v_exp_f32 v103, v103
    v_exp_f32 v104, v104
    s_nop 6
    v_mfma_f32_32x32x16_bf16 v[56:71], v[168:171], v[8:11], v[56:71]
    v_exp_f32 v105, v105
    v_exp_f32 v106, v106
    v_exp_f32 v107, v107
    v_exp_f32 v108, v108
    v_smfmac_f32_32x32x32_bf16 v[136:151], v[192:195], v[96:103], v246
    s_add_u32 m0, s34, 65536
    s_add_u32 s35, s35, 16384
    buffer_load_dwordx4 v21, s[12:15], s35 offen offset:0 sc1 lds
    buffer_load_dwordx4 v21, s[12:15], s35 offen offset:1024 sc1 lds
    v_exp_f32 v109, v109
    v_exp_f32 v110, v110
    v_exp_f32 v111, v111
    v_exp_f32 v112, v112
    v_mfma_f32_32x32x16_bf16 v[72:87], v[168:171], v[12:15], v[72:87]
    v_exp_f32 v113, v113
    v_exp_f32 v114, v114
    v_exp_f32 v115, v115
    v_exp_f32 v116, v116
    v_smfmac_f32_32x32x32_bf16 v[152:167], v[188:191], v[104:111], v246
    v_exp_f32 v117, v117
    v_exp_f32 v118, v118
    v_exp_f32 v119, v119
    v_exp_f32 v56, v56
    v_exp_f32 v57, v57
    v_smfmac_f32_32x32x32_bf16 v[152:167], v[192:195], v[112:119], v246
    s_waitcnt lgkmcnt(0)
    s_mov_b64 exec, s[50:51]
    ds_read_b128 v[188:191], v20 offset:15360
    ds_read_b128 v[192:195], v20 offset:16000
    s_mov_b64 exec, -1
    ds_read_b128 v[168:171], v18 offset:20480
    ds_read_b64 v[176:177], v19 offset:20480
    v_exp_f32 v58, v58
    v_exp_f32 v59, v59
    v_exp_f32 v60, v60
    v_mfma_f32_32x32x4_2b_bf16 v[88:119], v[178:179], v[16:17], v[24:55]
    v_exp_f32 v61, v61
    v_exp_f32 v62, v62
    v_exp_f32 v63, v63
    v_exp_f32 v64, v64
    v_exp_f32 v65, v65
    v_exp_f32 v66, v66
    v_exp_f32 v67, v67
    v_exp_f32 v68, v68
    v_smfmac_f32_32x32x32_bf16 v[136:151], v[180:183], v[56:63], v246
    v_exp_f32 v69, v69
    v_exp_f32 v70, v70
    v_exp_f32 v71, v71
    v_exp_f32 v72, v72
    s_nop 6
    v_mfma_f32_32x32x16_bf16 v[88:103], v[172:175], v[8:11], v[88:103]
    v_exp_f32 v73, v73
    v_exp_f32 v74, v74
    v_exp_f32 v75, v75
    v_exp_f32 v76, v76
    v_smfmac_f32_32x32x32_bf16 v[136:151], v[184:187], v[64:71], v246
    s_add_u32 m0, s34, 81920
    s_add_u32 s35, s35, 16384
    buffer_load_dwordx4 v21, s[12:15], s35 offen offset:0 sc1 lds
    buffer_load_dwordx4 v21, s[12:15], s35 offen offset:1024 sc1 lds
    v_exp_f32 v77, v77
    v_exp_f32 v78, v78
    v_exp_f32 v79, v79
    v_exp_f32 v80, v80
    v_mfma_f32_32x32x16_bf16 v[104:119], v[172:175], v[12:15], v[104:119]
    v_exp_f32 v81, v81
    v_exp_f32 v82, v82
    v_exp_f32 v83, v83
    v_exp_f32 v84, v84
    v_smfmac_f32_32x32x32_bf16 v[152:167], v[180:183], v[72:79], v246
    v_exp_f32 v85, v85
    v_exp_f32 v86, v86
    v_exp_f32 v87, v87
    v_exp_f32 v88, v88
    v_exp_f32 v89, v89
    v_smfmac_f32_32x32x32_bf16 v[152:167], v[184:187], v[80:87], v246
    s_waitcnt lgkmcnt(0)
    s_mov_b64 exec, s[50:51]
    ds_read_b128 v[180:183], v20 offset:20480
    ds_read_b128 v[184:187], v20 offset:21120
    s_mov_b64 exec, -1
    ds_read_b128 v[172:175], v18 offset:25600
    ds_read_b64 v[178:179], v19 offset:25600
    v_exp_f32 v90, v90
    v_exp_f32 v91, v91
    v_exp_f32 v92, v92
    v_mfma_f32_32x32x4_2b_bf16 v[56:87], v[176:177], v[16:17], v[24:55]
    v_exp_f32 v93, v93
    v_exp_f32 v94, v94
    v_exp_f32 v95, v95
    v_exp_f32 v96, v96
    v_exp_f32 v97, v97
    v_exp_f32 v98, v98
    v_exp_f32 v99, v99
    v_exp_f32 v100, v100
    v_smfmac_f32_32x32x32_bf16 v[136:151], v[188:191], v[88:95], v246
    v_exp_f32 v101, v101
    v_exp_f32 v102, v102
    v_exp_f32 v103, v103
    v_exp_f32 v104, v104
    s_nop 6
    v_mfma_f32_32x32x16_bf16 v[56:71], v[168:171], v[8:11], v[56:71]
    v_exp_f32 v105, v105
    v_exp_f32 v106, v106
    v_exp_f32 v107, v107
    v_exp_f32 v108, v108
    v_smfmac_f32_32x32x32_bf16 v[136:151], v[192:195], v[96:103], v246
    s_add_u32 m0, s34, 98304
    s_add_u32 s35, s35, 16384
    buffer_load_dwordx4 v21, s[12:15], s35 offen offset:0 sc1 lds
    buffer_load_dwordx4 v21, s[12:15], s35 offen offset:1024 sc1 lds
    v_exp_f32 v109, v109
    v_exp_f32 v110, v110
    v_exp_f32 v111, v111
    v_exp_f32 v112, v112
    v_mfma_f32_32x32x16_bf16 v[72:87], v[168:171], v[12:15], v[72:87]
    v_exp_f32 v113, v113
    v_exp_f32 v114, v114
    v_exp_f32 v115, v115
    v_exp_f32 v116, v116
    v_smfmac_f32_32x32x32_bf16 v[152:167], v[188:191], v[104:111], v246
    v_exp_f32 v117, v117
    v_exp_f32 v118, v118
    v_exp_f32 v119, v119
    v_exp_f32 v56, v56
    v_exp_f32 v57, v57
    v_smfmac_f32_32x32x32_bf16 v[152:167], v[192:195], v[112:119], v246
    s_waitcnt vmcnt(4)
    s_barrier
    s_waitcnt lgkmcnt(0)
    s_mov_b64 exec, s[50:51]
H_block_kernel_seg3:
H_block_kernel_13:
    s_cbranch_execz H_block_kernel_14
    ds_read_b128 v[188:191], v20 offset:25600
    ds_read_b128 v[192:195], v20 offset:26240
    s_mov_b64 exec, -1
    ds_read_b128 v[168:171], v18 offset:30720
    ds_read_b64 v[176:177], v19 offset:30720
    v_exp_f32 v58, v58
    v_exp_f32 v59, v59
    v_exp_f32 v60, v60
    v_mfma_f32_32x32x4_2b_bf16 v[88:119], v[178:179], v[16:17], v[24:55]
    v_exp_f32 v61, v61
    v_exp_f32 v62, v62
    v_exp_f32 v63, v63
    v_exp_f32 v64, v64
    v_exp_f32 v65, v65
    v_exp_f32 v66, v66
    v_exp_f32 v67, v67
    v_exp_f32 v68, v68
    v_smfmac_f32_32x32x32_bf16 v[136:151], v[180:183], v[56:63], v246
    v_exp_f32 v69, v69
    v_exp_f32 v70, v70
    v_exp_f32 v71, v71
    v_exp_f32 v72, v72
    s_nop 6
    v_mfma_f32_32x32x16_bf16 v[88:103], v[172:175], v[8:11], v[88:103]
    v_exp_f32 v73, v73
    v_exp_f32 v74, v74
    v_exp_f32 v75, v75
    v_exp_f32 v76, v76
    v_smfmac_f32_32x32x32_bf16 v[136:151], v[184:187], v[64:71], v246
    s_add_u32 m0, s34, 114688
    s_add_u32 s35, s35, 16384
    buffer_load_dwordx4 v21, s[12:15], s35 offen offset:0 sc1 lds
    buffer_load_dwordx4 v21, s[12:15], s35 offen offset:1024 sc1 lds
    v_exp_f32 v77, v77
    v_exp_f32 v78, v78
    v_exp_f32 v79, v79
    v_exp_f32 v80, v80
    v_mfma_f32_32x32x16_bf16 v[104:119], v[172:175], v[12:15], v[104:119]
    v_exp_f32 v81, v81
    v_exp_f32 v82, v82
    v_exp_f32 v83, v83
    v_exp_f32 v84, v84
    v_smfmac_f32_32x32x32_bf16 v[152:167], v[180:183], v[72:79], v246
    v_mov_b32 v120, -1
    v_mov_b32 v121, -1
    v_mov_b32 v122, -1
    v_mov_b32 v123, -1
    buffer_store_dwordx4 v[120:123], v244, s[12:15], s24 offen sc1
    s_mov_b64 exec, 0xffffffff
    buffer_store_dwordx2 v[120:121], v245, s[12:15], s25 offen sc1
    s_mov_b64 exec, -1
    v_exp_f32 v85, v85
    v_exp_f32 v86, v86
    v_exp_f32 v87, v87
    v_exp_f32 v88, v88
    v_exp_f32 v89, v89
    v_smfmac_f32_32x32x32_bf16 v[152:167], v[184:187], v[80:87], v246
    s_waitcnt lgkmcnt(0)
    s_mov_b64 exec, s[50:51]
    ds_read_b128 v[180:183], v20 offset:30720
    ds_read_b128 v[184:187], v20 offset:31360
    s_mov_b64 exec, -1
    ds_read_b128 v[172:175], v18 offset:35840
    ds_read_b64 v[178:179], v19 offset:35840
    v_exp_f32 v90, v90
    v_exp_f32 v91, v91
    v_exp_f32 v92, v92
    v_mfma_f32_32x32x4_2b_bf16 v[56:87], v[176:177], v[16:17], v[24:55]
    v_exp_f32 v93, v93
    v_exp_f32 v94, v94
    v_exp_f32 v95, v95
    v_exp_f32 v96, v96
    v_exp_f32 v97, v97
    v_exp_f32 v98, v98
    v_exp_f32 v99, v99
    v_exp_f32 v100, v100
    v_smfmac_f32_32x32x32_bf16 v[136:151], v[188:191], v[88:95], v246
    v_exp_f32 v101, v101
    v_exp_f32 v102, v102
    v_exp_f32 v103, v103
    v_exp_f32 v104, v104
    s_nop 6
    v_mfma_f32_32x32x16_bf16 v[56:71], v[168:171], v[8:11], v[56:71]
    v_exp_f32 v105, v105
    v_exp_f32 v106, v106
    v_exp_f32 v107, v107
    v_exp_f32 v108, v108
    v_smfmac_f32_32x32x32_bf16 v[136:151], v[192:195], v[96:103], v246
    s_add_u32 m0, s34, 131072
    s_add_u32 s35, s35, 16384
    buffer_load_dwordx4 v21, s[12:15], s35 offen offset:0 sc1 lds
    buffer_load_dwordx4 v21, s[12:15], s35 offen offset:1024 sc1 lds
    v_exp_f32 v109, v109
    v_exp_f32 v110, v110
    v_exp_f32 v111, v111
    v_exp_f32 v112, v112
    v_mfma_f32_32x32x16_bf16 v[72:87], v[168:171], v[12:15], v[72:87]
    v_exp_f32 v113, v113
    v_exp_f32 v114, v114
    v_exp_f32 v115, v115
    v_exp_f32 v116, v116
    v_smfmac_f32_32x32x32_bf16 v[152:167], v[188:191], v[104:111], v246
    v_exp_f32 v117, v117
    v_exp_f32 v118, v118
    v_exp_f32 v119, v119
    v_exp_f32 v56, v56
    v_exp_f32 v57, v57
    v_smfmac_f32_32x32x32_bf16 v[152:167], v[192:195], v[112:119], v246
    s_waitcnt lgkmcnt(0)
    s_mov_b64 exec, s[50:51]
    ds_read_b128 v[188:191], v20 offset:35840
    ds_read_b128 v[192:195], v20 offset:36480
    s_mov_b64 exec, -1
    v_add_u32 v18, 40960, v18
    v_add_u32 v19, 40960, v19
    ds_read_b128 v[168:171], v18 offset:0
    ds_read_b64 v[176:177], v19 offset:0
    v_exp_f32 v58, v58
    v_exp_f32 v59, v59
    v_exp_f32 v60, v60
    v_mfma_f32_32x32x4_2b_bf16 v[88:119], v[178:179], v[16:17], v[24:55]
    v_exp_f32 v61, v61
    v_exp_f32 v62, v62
    v_exp_f32 v63, v63
    v_exp_f32 v64, v64
    v_exp_f32 v65, v65
    v_exp_f32 v66, v66
    v_exp_f32 v67, v67
    v_exp_f32 v68, v68
    v_smfmac_f32_32x32x32_bf16 v[136:151], v[180:183], v[56:63], v246
    v_exp_f32 v69, v69
    v_exp_f32 v70, v70
    v_exp_f32 v71, v71
    v_exp_f32 v72, v72
    s_nop 6
    v_mfma_f32_32x32x16_bf16 v[88:103], v[172:175], v[8:11], v[88:103]
    v_exp_f32 v73, v73
    v_exp_f32 v74, v74
    v_exp_f32 v75, v75
    v_exp_f32 v76, v76
    v_smfmac_f32_32x32x32_bf16 v[136:151], v[184:187], v[64:71], v246
    s_add_u32 m0, s34, 147456
    s_add_u32 s35, s35, 16384
    buffer_load_dwordx4 v21, s[12:15], s35 offen offset:0 sc1 lds
    buffer_load_dwordx4 v21, s[12:15], s35 offen offset:1024 sc1 lds
    v_exp_f32 v77, v77
    v_exp_f32 v78, v78
    v_exp_f32 v79, v79
    v_exp_f32 v80, v80
    v_mfma_f32_32x32x16_bf16 v[104:119], v[172:175], v[12:15], v[104:119]
    v_exp_f32 v81, v81
    v_exp_f32 v82, v82
    v_exp_f32 v83, v83
    v_exp_f32 v84, v84
    v_smfmac_f32_32x32x32_bf16 v[152:167], v[180:183], v[72:79], v246
    v_exp_f32 v85, v85
    v_exp_f32 v86, v86
    v_exp_f32 v87, v87
    v_exp_f32 v88, v88
    v_exp_f32 v89, v89
    v_smfmac_f32_32x32x32_bf16 v[152:167], v[184:187], v[80:87], v246
    buffer_store_dwordx4 v[120:123], v21, s[12:15], s55 offen sc1
    s_cmp_lt_u32 s30, 4
    s_cselect_b64 exec, 0xff, 0
    buffer_store_dwordx4 v[120:123], v21, s[12:15], s54 offen sc1
    s_cselect_b32 exec_lo, 0, -1
    buffer_store_dwordx4 v[120:123], v21, s[12:15], s56 offen offset:2048 sc1
    s_mov_b64 exec, -1
    s_waitcnt lgkmcnt(0)
    v_add_u32 v20, 40960, v20
    s_mov_b64 exec, s[50:51]
    ds_read_b128 v[180:183], v20 offset:0
    ds_read_b128 v[184:187], v20 offset:640
    s_mov_b64 exec, -1
    ds_read_b128 v[172:175], v18 offset:5120
    ds_read_b64 v[178:179], v19 offset:5120
    v_exp_f32 v90, v90
    v_exp_f32 v91, v91
    v_exp_f32 v92, v92
    v_mfma_f32_32x32x4_2b_bf16 v[56:87], v[176:177], v[16:17], v[24:55]
    v_exp_f32 v93, v93
    v_exp_f32 v94, v94
    v_exp_f32 v95, v95
    v_exp_f32 v96, v96
    v_exp_f32 v97, v97
    v_exp_f32 v98, v98
    v_exp_f32 v99, v99
    v_exp_f32 v100, v100
    v_smfmac_f32_32x32x32_bf16 v[136:151], v[188:191], v[88:95], v246
    v_exp_f32 v101, v101
    v_exp_f32 v102, v102
    v_exp_f32 v103, v103
    v_exp_f32 v104, v104
    s_nop 6
H_block_kernel_14:
    s_cbranch_execz H_block_kernel_15
    v_mfma_f32_32x32x16_bf16 v[56:71], v[168:171], v[8:11], v[56:71]
    v_exp_f32 v105, v105
    v_exp_f32 v106, v106
    v_exp_f32 v107, v107
    v_exp_f32 v108, v108
    v_smfmac_f32_32x32x32_bf16 v[136:151], v[192:195], v[96:103], v246
    v_exp_f32 v109, v109
    v_exp_f32 v110, v110
    v_exp_f32 v111, v111
    v_exp_f32 v112, v112
    v_mfma_f32_32x32x16_bf16 v[72:87], v[168:171], v[12:15], v[72:87]
    v_exp_f32 v113, v113
    v_exp_f32 v114, v114
    v_exp_f32 v115, v115
    v_exp_f32 v116, v116
    v_smfmac_f32_32x32x32_bf16 v[152:167], v[188:191], v[104:111], v246
    v_exp_f32 v117, v117
    v_exp_f32 v118, v118
    v_exp_f32 v119, v119
    s_waitcnt vmcnt(3)
    s_barrier
    s_setprio 1
    s_cmp_lg_u32 s47, 0
    s_cbranch_scc1 L_block_kernel_nf_62
    s_add_u32 m0, s9, 0
    s_nop 0
    buffer_load_dwordx4 v232, s[16:19], s4 offen lds
    s_add_u32 m0, s9, 1024
    s_nop 0
    buffer_load_dwordx4 v232, s[16:19], s5 offen lds
    s_add_u32 m0, s9, 2048
    s_nop 0
    buffer_load_dwordx4 v232, s[16:19], s6 offen lds
    s_add_u32 m0, s9, 3072
    s_nop 0
    buffer_load_dwordx4 v232, s[16:19], s7 offen lds
    s_add_u32 m0, s9, 4096
    s_nop 0
    buffer_load_dwordx4 v233, s[16:19], s8 offen lds
L_block_kernel_nf_62:
    s_branch L_block_kernel_in_63
L_block_kernel_loop_54:
    s_cmp_eq_u32 s36, s39
    s_cbranch_scc1 L_block_kernel_sd_64
L_block_kernel_sr_65:
    v_add_u32 v241, 1, v241
    ds_write_b32 v240, v241
L_block_kernel_in_63:
    v_exp_f32 v56, v56
    v_exp_f32 v57, v57
    v_smfmac_f32_32x32x32_bf16 v[152:167], v[192:195], v[112:119], v246
    s_waitcnt lgkmcnt(0)
    s_mov_b64 exec, s[50:51]
    ds_read_b128 v[188:191], v20 offset:5120
    ds_read_b128 v[192:195], v20 offset:5760
    s_mov_b64 exec, -1
    ds_read_b128 v[168:171], v18 offset:10240
    ds_read_b64 v[176:177], v19 offset:10240
    v_exp_f32 v58, v58
    v_exp_f32 v59, v59
    v_exp_f32 v60, v60
    v_mfma_f32_32x32x4_2b_bf16 v[88:119], v[178:179], v[16:17], v[24:55]
    v_exp_f32 v61, v61
    v_exp_f32 v62, v62
    v_exp_f32 v63, v63
    v_exp_f32 v64, v64
    v_exp_f32 v65, v65
    v_exp_f32 v66, v66
    v_exp_f32 v67, v67
    v_exp_f32 v68, v68
    v_smfmac_f32_32x32x32_bf16 v[136:151], v[180:183], v[56:63], v246
    v_exp_f32 v69, v69
    v_exp_f32 v70, v70
    v_exp_f32 v71, v71
    v_exp_f32 v72, v72
    s_nop 6
    v_mfma_f32_32x32x16_bf16 v[88:103], v[172:175], v[8:11], v[88:103]
    v_exp_f32 v73, v73
    v_exp_f32 v74, v74
    v_exp_f32 v75, v75
    v_exp_f32 v76, v76
    v_smfmac_f32_32x32x32_bf16 v[136:151], v[184:187], v[64:71], v246
    v_exp_f32 v77, v77
    v_exp_f32 v78, v78
    v_exp_f32 v79, v79
    v_exp_f32 v80, v80
    v_mfma_f32_32x32x16_bf16 v[104:119], v[172:175], v[12:15], v[104:119]
    v_exp_f32 v81, v81
    v_exp_f32 v82, v82
    v_exp_f32 v83, v83
    v_exp_f32 v84, v84
    v_smfmac_f32_32x32x32_bf16 v[152:167], v[180:183], v[72:79], v246
    v_exp_f32 v85, v85
    v_exp_f32 v86, v86
    v_exp_f32 v87, v87
    v_exp_f32 v88, v88
    v_exp_f32 v89, v89
    v_smfmac_f32_32x32x32_bf16 v[152:167], v[184:187], v[80:87], v246
    s_waitcnt lgkmcnt(0)
    s_mov_b64 exec, s[50:51]
    ds_read_b128 v[180:183], v20 offset:10240
    ds_read_b128 v[184:187], v20 offset:10880
    s_mov_b64 exec, -1
    ds_read_b128 v[172:175], v18 offset:15360
    ds_read_b64 v[178:179], v19 offset:15360
    v_exp_f32 v90, v90
    v_exp_f32 v91, v91
    v_exp_f32 v92, v92
    v_mfma_f32_32x32x4_2b_bf16 v[56:87], v[176:177], v[16:17], v[24:55]
    v_exp_f32 v93, v93
    v_exp_f32 v94, v94
    v_exp_f32 v95, v95
    v_exp_f32 v96, v96
    v_exp_f32 v97, v97
    v_exp_f32 v98, v98
    v_exp_f32 v99, v99
    v_exp_f32 v100, v100
    v_smfmac_f32_32x32x32_bf16 v[136:151], v[188:191], v[88:95], v246
    v_exp_f32 v101, v101
    v_exp_f32 v102, v102
    v_exp_f32 v103, v103
    v_exp_f32 v104, v104
    s_nop 6
    v_mfma_f32_32x32x16_bf16 v[56:71], v[168:171], v[8:11], v[56:71]
    v_exp_f32 v105, v105
    v_exp_f32 v106, v106
    v_exp_f32 v107, v107
    v_exp_f32 v108, v108
    v_smfmac_f32_32x32x32_bf16 v[136:151], v[192:195], v[96:103], v246
    v_exp_f32 v109, v109
    v_exp_f32 v110, v110
    v_exp_f32 v111, v111
    v_exp_f32 v112, v112
    v_mfma_f32_32x32x16_bf16 v[72:87], v[168:171], v[12:15], v[72:87]
    v_exp_f32 v113, v113
    v_exp_f32 v114, v114
    v_exp_f32 v115, v115
    v_exp_f32 v116, v116
    v_smfmac_f32_32x32x32_bf16 v[152:167], v[188:191], v[104:111], v246
    v_exp_f32 v117, v117
    v_exp_f32 v118, v118
    v_exp_f32 v119, v119
    v_exp_f32 v56, v56
    v_exp_f32 v57, v57
    v_smfmac_f32_32x32x32_bf16 v[152:167], v[192:195], v[112:119], v246
    s_waitcnt lgkmcnt(0)
    s_mov_b64 exec, s[50:51]
    ds_read_b128 v[188:191], v20 offset:15360
    ds_read_b128 v[192:195], v20 offset:16000
    s_mov_b64 exec, -1
    ds_read_b128 v[168:171], v18 offset:20480
    ds_read_b64 v[176:177], v19 offset:20480
    v_exp_f32 v58, v58
    v_exp_f32 v59, v59
    v_exp_f32 v60, v60
    v_mfma_f32_32x32x4_2b_bf16 v[88:119], v[178:179], v[16:17], v[24:55]
    v_exp_f32 v61, v61
    v_exp_f32 v62, v62
    v_exp_f32 v63, v63
    v_exp_f32 v64, v64
    v_exp_f32 v65, v65
    v_exp_f32 v66, v66
    v_exp_f32 v67, v67
    v_exp_f32 v68, v68
    v_smfmac_f32_32x32x32_bf16 v[136:151], v[180:183], v[56:63], v246
    v_exp_f32 v69, v69
    v_exp_f32 v70, v70
    v_exp_f32 v71, v71
    v_exp_f32 v72, v72
    s_nop 6
    v_mfma_f32_32x32x16_bf16 v[88:103], v[172:175], v[8:11], v[88:103]
    v_exp_f32 v73, v73
    v_exp_f32 v74, v74
    v_exp_f32 v75, v75
    v_exp_f32 v76, v76
    v_smfmac_f32_32x32x32_bf16 v[136:151], v[184:187], v[64:71], v246
    s_cmp_eq_u32 s36, s23
    s_cbranch_scc1 L_block_kernel_sd_66
L_block_kernel_sr_67:
    v_exp_f32 v77, v77
    v_exp_f32 v78, v78
    v_exp_f32 v79, v79
    v_exp_f32 v80, v80
    v_mfma_f32_32x32x16_bf16 v[104:119], v[172:175], v[12:15], v[104:119]
    v_exp_f32 v81, v81
    v_exp_f32 v82, v82
    v_exp_f32 v83, v83
    v_exp_f32 v84, v84
    v_smfmac_f32_32x32x32_bf16 v[152:167], v[180:183], v[72:79], v246
    v_exp_f32 v85, v85
    v_exp_f32 v86, v86
    v_exp_f32 v87, v87
    v_exp_f32 v88, v88
    v_exp_f32 v89, v89
    v_smfmac_f32_32x32x32_bf16 v[152:167], v[184:187], v[80:87], v246
    s_waitcnt lgkmcnt(0)
    s_mov_b64 exec, s[50:51]
    ds_read_b128 v[180:183], v20 offset:20480
    ds_read_b128 v[184:187], v20 offset:21120
    s_mov_b64 exec, -1
    ds_read_b128 v[172:175], v18 offset:25600
    ds_read_b64 v[178:179], v19 offset:25600
    v_exp_f32 v90, v90
    v_exp_f32 v91, v91
    v_exp_f32 v92, v92
    v_mfma_f32_32x32x4_2b_bf16 v[56:87], v[176:177], v[16:17], v[24:55]
    v_exp_f32 v93, v93
H_block_kernel_15:
    s_cbranch_execz H_block_kernel_16
    v_exp_f32 v94, v94
    v_exp_f32 v95, v95
    v_exp_f32 v96, v96
    v_exp_f32 v97, v97
    v_exp_f32 v98, v98
    v_exp_f32 v99, v99
    v_exp_f32 v100, v100
    v_smfmac_f32_32x32x32_bf16 v[136:151], v[188:191], v[88:95], v246
    v_exp_f32 v101, v101
    v_exp_f32 v102, v102
    v_exp_f32 v103, v103
    v_exp_f32 v104, v104
    s_nop 6
    v_mfma_f32_32x32x16_bf16 v[56:71], v[168:171], v[8:11], v[56:71]
    v_exp_f32 v105, v105
    v_exp_f32 v106, v106
    v_exp_f32 v107, v107
    v_exp_f32 v108, v108
    v_smfmac_f32_32x32x32_bf16 v[136:151], v[192:195], v[96:103], v246
    v_exp_f32 v109, v109
    v_exp_f32 v110, v110
    v_exp_f32 v111, v111
    v_exp_f32 v112, v112
    v_mfma_f32_32x32x16_bf16 v[72:87], v[168:171], v[12:15], v[72:87]
    v_exp_f32 v113, v113
    v_exp_f32 v114, v114
    v_exp_f32 v115, v115
    v_exp_f32 v116, v116
    v_smfmac_f32_32x32x32_bf16 v[152:167], v[188:191], v[104:111], v246
    v_exp_f32 v117, v117
    v_exp_f32 v118, v118
    v_exp_f32 v119, v119
    v_exp_f32 v56, v56
    v_exp_f32 v57, v57
    v_smfmac_f32_32x32x32_bf16 v[152:167], v[192:195], v[112:119], v246
    s_waitcnt lgkmcnt(0)
    s_mov_b64 exec, s[50:51]
    ds_read_b128 v[188:191], v20 offset:25600
    ds_read_b128 v[192:195], v20 offset:26240
    s_mov_b64 exec, -1
    ds_read_b128 v[168:171], v18 offset:30720
    ds_read_b64 v[176:177], v19 offset:30720
    v_exp_f32 v58, v58
    v_exp_f32 v59, v59
    v_exp_f32 v60, v60
    v_mfma_f32_32x32x4_2b_bf16 v[88:119], v[178:179], v[16:17], v[24:55]
    v_exp_f32 v61, v61
    v_exp_f32 v62, v62
    v_exp_f32 v63, v63
    v_exp_f32 v64, v64
    v_exp_f32 v65, v65
    v_exp_f32 v66, v66
    v_exp_f32 v67, v67
    v_exp_f32 v68, v68
    v_smfmac_f32_32x32x32_bf16 v[136:151], v[180:183], v[56:63], v246
    v_exp_f32 v69, v69
    v_exp_f32 v70, v70
    v_exp_f32 v71, v71
    v_exp_f32 v72, v72
    s_nop 6
    v_mfma_f32_32x32x16_bf16 v[88:103], v[172:175], v[8:11], v[88:103]
    v_exp_f32 v73, v73
    v_exp_f32 v74, v74
    v_exp_f32 v75, v75
    v_exp_f32 v76, v76
    v_smfmac_f32_32x32x32_bf16 v[136:151], v[184:187], v[64:71], v246
    s_cmp_eq_u32 s36, s47
    s_cbranch_scc1 L_block_kernel_sd_68
L_block_kernel_sr_69:
    v_exp_f32 v77, v77
    v_exp_f32 v78, v78
    v_exp_f32 v79, v79
    v_exp_f32 v80, v80
    v_mfma_f32_32x32x16_bf16 v[104:119], v[172:175], v[12:15], v[104:119]
    v_exp_f32 v81, v81
    v_exp_f32 v82, v82
    v_exp_f32 v83, v83
    v_exp_f32 v84, v84
    v_smfmac_f32_32x32x32_bf16 v[152:167], v[180:183], v[72:79], v246
    v_exp_f32 v85, v85
    v_exp_f32 v86, v86
    v_exp_f32 v87, v87
    v_exp_f32 v88, v88
    v_exp_f32 v89, v89
    v_smfmac_f32_32x32x32_bf16 v[152:167], v[184:187], v[80:87], v246
    s_cmp_lg_u32 s36, 2
    s_cbranch_scc1 L_block_kernel_np_70
    s_setprio 0
L_block_kernel_np_70:
    s_waitcnt lgkmcnt(0)
    s_mov_b64 exec, s[50:51]
    ds_read_b128 v[180:183], v20 offset:30720
    ds_read_b128 v[184:187], v20 offset:31360
    s_mov_b64 exec, -1
    ds_read_b128 v[172:175], v18 offset:35840
    ds_read_b64 v[178:179], v19 offset:35840
    v_exp_f32 v90, v90
    v_exp_f32 v91, v91
    v_exp_f32 v92, v92
    v_mfma_f32_32x32x4_2b_bf16 v[56:87], v[176:177], v[16:17], v[24:55]
    v_exp_f32 v93, v93
    v_exp_f32 v94, v94
    v_exp_f32 v95, v95
    v_exp_f32 v96, v96
    v_exp_f32 v97, v97
    v_exp_f32 v98, v98
    v_exp_f32 v99, v99
    v_exp_f32 v100, v100
    v_smfmac_f32_32x32x32_bf16 v[136:151], v[188:191], v[88:95], v246
    v_exp_f32 v101, v101
    v_exp_f32 v102, v102
    v_exp_f32 v103, v103
    v_exp_f32 v104, v104
    s_nop 6
    v_mfma_f32_32x32x16_bf16 v[56:71], v[168:171], v[8:11], v[56:71]
    v_exp_f32 v105, v105
    v_exp_f32 v106, v106
    v_exp_f32 v107, v107
    v_exp_f32 v108, v108
    v_smfmac_f32_32x32x32_bf16 v[136:151], v[192:195], v[96:103], v246
    s_cmp_eq_u32 s36, s47
    s_cbranch_scc1 L_block_kernel_sd_71
L_block_kernel_sr_72:
    v_exp_f32 v109, v109
    v_exp_f32 v110, v110
    v_exp_f32 v111, v111
    v_exp_f32 v112, v112
    v_mfma_f32_32x32x16_bf16 v[72:87], v[168:171], v[12:15], v[72:87]
    v_exp_f32 v113, v113
    v_exp_f32 v114, v114
    v_exp_f32 v115, v115
    v_exp_f32 v116, v116
    v_smfmac_f32_32x32x32_bf16 v[152:167], v[188:191], v[104:111], v246
    s_cmp_lg_u32 s36, s49
    s_cbranch_scc1 L_block_kernel_na_73
    s_mov_b64 exec, 7
    buffer_atomic_or v226, v227, s[12:15], s48 offen sc0 sc1
    s_mov_b64 exec, -1
L_block_kernel_na_73:
    v_exp_f32 v117, v117
    v_exp_f32 v118, v118
    v_exp_f32 v119, v119
    v_exp_f32 v56, v56
    v_exp_f32 v57, v57
    v_smfmac_f32_32x32x32_bf16 v[152:167], v[192:195], v[112:119], v246
    s_waitcnt lgkmcnt(0)
    s_mov_b64 exec, s[50:51]
    ds_read_b128 v[188:191], v20 offset:35840
    ds_read_b128 v[192:195], v20 offset:36480
    s_mov_b64 exec, -1
    v_add_u32 v18, 40960, v18
    v_add_u32 v19, 40960, v19
    ds_read_b128 v[168:171], v18 offset:0
    ds_read_b64 v[176:177], v19 offset:0
    v_exp_f32 v58, v58
    v_exp_f32 v59, v59
    v_exp_f32 v60, v60
    v_mfma_f32_32x32x4_2b_bf16 v[88:119], v[178:179], v[16:17], v[24:55]
    v_exp_f32 v61, v61
    v_exp_f32 v62, v62
    v_exp_f32 v63, v63
    v_exp_f32 v64, v64
    v_exp_f32 v65, v65
    v_exp_f32 v66, v66
    v_exp_f32 v67, v67
    v_exp_f32 v68, v68
    v_smfmac_f32_32x32x32_bf16 v[136:151], v[180:183], v[56:63], v246
    v_exp_f32 v69, v69
    v_exp_f32 v70, v70
    v_exp_f32 v71, v71
    v_exp_f32 v72, v72
    s_nop 6
    v_mfma_f32_32x32x16_bf16 v[88:103], v[172:175], v[8:11], v[88:103]
    v_exp_f32 v73, v73
    v_exp_f32 v74, v74
    v_exp_f32 v75, v75
    v_exp_f32 v76, v76
    v_smfmac_f32_32x32x32_bf16 v[136:151], v[184:187], v[64:71], v246
    s_cmp_eq_u32 s36, s53
    s_cbranch_scc1 L_block_kernel_sd_74
L_block_kernel_sr_75:
    v_exp_f32 v77, v77
    v_exp_f32 v78, v78
    v_exp_f32 v79, v79
    v_exp_f32 v80, v80
    v_mfma_f32_32x32x16_bf16 v[104:119], v[172:175], v[12:15], v[104:119]
    v_exp_f32 v81, v81
    v_exp_f32 v82, v82
    v_exp_f32 v83, v83
    v_exp_f32 v84, v84
    v_smfmac_f32_32x32x32_bf16 v[152:167], v[180:183], v[72:79], v246
    v_exp_f32 v85, v85
    v_exp_f32 v86, v86
    v_exp_f32 v87, v87
    v_exp_f32 v88, v88
    v_exp_f32 v89, v89
    v_smfmac_f32_32x32x32_bf16 v[152:167], v[184:187], v[80:87], v246
    s_waitcnt lgkmcnt(0)
    v_add_u32 v20, 40960, v20
    s_mov_b64 exec, s[50:51]
    ds_read_b128 v[180:183], v20 offset:0
    ds_read_b128 v[184:187], v20 offset:640
    s_mov_b64 exec, -1
    ds_read_b128 v[172:175], v18 offset:5120
    ds_read_b64 v[178:179], v19 offset:5120
    v_exp_f32 v90, v90
    v_exp_f32 v91, v91
    v_exp_f32 v92, v92
    v_mfma_f32_32x32x4_2b_bf16 v[56:87], v[176:177], v[16:17], v[24:55]
    v_exp_f32 v93, v93
    v_exp_f32 v94, v94
    v_exp_f32 v95, v95
H_block_kernel_16:
    s_cbranch_execz H_block_kernel_end
    v_exp_f32 v96, v96
    v_exp_f32 v97, v97
    v_exp_f32 v98, v98
    v_exp_f32 v99, v99
    v_exp_f32 v100, v100
    v_smfmac_f32_32x32x32_bf16 v[136:151], v[188:191], v[88:95], v246
    v_exp_f32 v101, v101
    v_exp_f32 v102, v102
    v_exp_f32 v103, v103
    v_exp_f32 v104, v104
    s_nop 6
    v_mfma_f32_32x32x16_bf16 v[56:71], v[168:171], v[8:11], v[56:71]
    v_exp_f32 v105, v105
    v_exp_f32 v106, v106
    v_exp_f32 v107, v107
    v_exp_f32 v108, v108
    v_smfmac_f32_32x32x32_bf16 v[136:151], v[192:195], v[96:103], v246
    v_exp_f32 v109, v109
    v_exp_f32 v110, v110
    v_exp_f32 v111, v111
    v_exp_f32 v112, v112
    v_mfma_f32_32x32x16_bf16 v[72:87], v[168:171], v[12:15], v[72:87]
    v_exp_f32 v113, v113
    v_exp_f32 v114, v114
    v_exp_f32 v115, v115
    v_exp_f32 v116, v116
    v_smfmac_f32_32x32x32_bf16 v[152:167], v[188:191], v[104:111], v246
    s_add_u32 s36, s36, 1
    s_cmp_lt_u32 s36, 3
    v_exp_f32 v117, v117
    v_exp_f32 v118, v118
    v_exp_f32 v119, v119
    s_cbranch_scc1 L_block_kernel_loop_54
    s_cmp_lt_u32 s30, 4
    v_smfmac_f32_32x32x32_bf16 v[152:167], v[192:195], v[112:119], v246
    s_movk_i32 s4, 20000
    s_cbranch_scc1 L_block_kernel_lead_76
Hb_block_kernel_seg0:
Hb_block_kernel_0:
    s_cbranch_execz Hb_block_kernel_1
L_block_kernel_mg_77:
    ds_read_b128 v[64:67], v242 offset:22528
    ds_read_b128 v[56:59], v242 offset:20480
    ds_read_b128 v[60:63], v242 offset:21504
    ds_read_b128 v[80:83], v242 offset:2048
    ds_read_b128 v[72:75], v242 offset:0
    ds_read_b128 v[76:79], v242 offset:1024
    s_sub_u32 s4, s4, 1
    s_cselect_b32 s6, -1, 0
    s_waitcnt lgkmcnt(5)
    v_cmp_eq_u32 vcc, -1, v67
    s_nop 0
    s_nor_b32 s6, s6, vcc_hi
    s_cbranch_scc1 L_block_kernel_mg_77
    v_cndmask_b32_e64 v67, v67, 0, vcc
L_block_kernel_epi_55:
    v_add_f32 v148, v144, v64
    v_add_f32 v149, v144, v64
    v_pk_add_f32 v[144:145], v[144:145], v[64:65]
    v_pk_add_f32 v[146:147], v[146:147], v[66:67]
    v_permlane32_swap_b32 v148, v149
    s_waitcnt lgkmcnt(3)
    v_pk_add_f32 v[136:137], v[136:137], v[56:57]
    v_rcp_f32 v148, v149
    v_pk_add_f32 v[138:139], v[138:139], v[58:59]
    v_pk_add_f32 v[140:141], v[140:141], v[60:61]
    v_pk_add_f32 v[142:143], v[142:143], v[62:63]
    s_waitcnt lgkmcnt(2)
    v_add_f32 v164, v160, v80
    v_add_f32 v165, v160, v80
    v_pk_add_f32 v[160:161], v[160:161], v[80:81]
    v_pk_add_f32 v[162:163], v[162:163], v[82:83]
    v_permlane32_swap_b32 v164, v165
    s_waitcnt lgkmcnt(0)
    v_pk_add_f32 v[152:153], v[152:153], v[72:73]
    v_rcp_f32 v164, v165
    v_pk_add_f32 v[154:155], v[154:155], v[74:75]
    v_pk_add_f32 v[156:157], v[156:157], v[76:77]
    v_pk_add_f32 v[158:159], v[158:159], v[78:79]
    v_mov_b32 v19, 0x5d800000
    v_pk_mul_f32 v[6:7], v[136:137], 0
    v_pk_fma_f32 v[6:7], v[138:139], 0, v[6:7]
    v_pk_fma_f32 v[6:7], v[140:141], 0, v[6:7]
    v_pk_fma_f32 v[6:7], v[142:143], 0, v[6:7]
    v_pk_fma_f32 v[6:7], v[144:145], 0, v[6:7]
    v_pk_fma_f32 v[6:7], v[146:147], 0, v[6:7]
    v_pk_fma_f32 v[6:7], v[148:149], 0, v[6:7]
    v_pk_fma_f32 v[6:7], v[152:153], 0, v[6:7]
    v_pk_fma_f32 v[6:7], v[154:155], 0, v[6:7]
    v_pk_fma_f32 v[6:7], v[156:157], 0, v[6:7]
    v_pk_fma_f32 v[6:7], v[158:159], 0, v[6:7]
    v_pk_fma_f32 v[6:7], v[160:161], 0, v[6:7]
    v_pk_fma_f32 v[6:7], v[162:163], 0, v[6:7]
    v_pk_fma_f32 v[6:7], v[164:165], 0, v[6:7]
    s_and_b32 s3, s22, 3
    s_bfe_u32 s6, s2, 0x30003
    s_lshl2_add_u32 s3, s6, s3
    s_lshl_b32 s3, s3, 8
    s_add_u32 s3, s3, 37945344
    v_max_f32 v18, v149, v165
    v_cmp_u_f32 s[42:43], v6, v7
    v_cmp_nlt_f32 s[40:41], v18, v19
    s_nop 0
    s_or_b64 s[40:41], s[40:41], s[42:43]
    s_or_b32 s40, s40, s41
    s_andn2_b32 s40, s40, s38
    s_cbranch_scc1 L_block_kernel_slow_56
L_block_kernel_sl3_79:
    s_mov_b64 exec, 1
    buffer_atomic_add v229, off, s[12:15], s3 sc1
    s_mov_b64 exec, -1
    v_pk_mul_f32 v[136:137], v[136:137], v[148:149] op_sel_hi:[1,0]
    v_pk_mul_f32 v[138:139], v[138:139], v[148:149] op_sel_hi:[1,0]
    v_pk_mul_f32 v[140:141], v[140:141], v[148:149] op_sel_hi:[1,0]
    v_pk_mul_f32 v[142:143], v[142:143], v[148:149] op_sel_hi:[1,0]
    v_pk_mul_f32 v[144:145], v[144:145], v[148:149] op_sel_hi:[1,0]
    v_pk_mul_f32 v[146:147], v[146:147], v[148:149] op_sel_hi:[1,0]
    v_cvt_pk_bf16_f32 v120, v136, v137
    v_cvt_pk_bf16_f32 v121, v138, v139
    v_cvt_pk_bf16_f32 v122, v140, v141
    v_cvt_pk_bf16_f32 v123, v142, v143
    buffer_store_dwordx4 v[120:123], v244, s[12:15], s24 offen sc1
    v_cvt_pk_bf16_f32 v124, v144, v145
    v_cvt_pk_bf16_f32 v125, v146, v147
    v_pk_mul_f32 v[152:153], v[152:153], v[164:165] op_sel_hi:[1,0]
    v_pk_mul_f32 v[154:155], v[154:155], v[164:165] op_sel_hi:[1,0]
    v_pk_mul_f32 v[156:157], v[156:157], v[164:165] op_sel_hi:[1,0]
    v_pk_mul_f32 v[158:159], v[158:159], v[164:165] op_sel_hi:[1,0]
    v_pk_mul_f32 v[160:161], v[160:161], v[164:165] op_sel_hi:[1,0]
    v_pk_mul_f32 v[162:163], v[162:163], v[164:165] op_sel_hi:[1,0]
    v_cvt_pk_bf16_f32 v128, v152, v153
    v_cvt_pk_bf16_f32 v129, v154, v155
    v_cvt_pk_bf16_f32 v130, v156, v157
    v_cvt_pk_bf16_f32 v131, v158, v159
    buffer_store_dwordx4 v[128:131], v244, s[12:15], s26 offen sc1
    v_cvt_pk_bf16_f32 v132, v160, v161
    v_cvt_pk_bf16_f32 v133, v162, v163
    s_mov_b64 exec, 0xffffffff
    buffer_store_dwordx2 v[124:125], v245, s[12:15], s25 offen sc1
    buffer_store_dwordx2 v[132:133], v245, s[12:15], s27 offen sc1
    s_mov_b64 exec, -1
    s_bfe_u32 s20, s2, 0x20001
    s_bfe_u32 s30, s2, 0x30003
    s_lshl3_add_u32 s20, s20, s30
    s_and_b32 s21, s2, 1
    s_lshr_b32 s31, s2, 6
    s_lshl2_add_u32 s21, s21, s31
    s_lshr_b32 s48, s20, 1
    s_lshl_b32 s49, s21, 1
    s_and_b32 s30, s30, 1
    s_add_u32 s49, s49, s30
    v_lshlrev_b32 v8, 4, v2
    s_and_b32 s23, s22, 3
    s_lshl_b32 s43, s48, 12
    s_add_u32 s43, s43, 37748736
    s_lshl_b32 s20, s20, 2
    s_add_u32 s20, s20, s23
    v_and_b32 v3, 15, v2
    v_lshrrev_b32 v4, 4, v2
    s_mul_i32 s42, s23, 5120
    s_mul_i32 s41, s21, 245760
    s_add_u32 s41, s41, s42
    s_add_u32 s41, s41, 30408704
    s_mul_i32 s24, s49, 251904
    s_add_u32 s24, s24, 33554432
    s_mov_b32 s18, 2621440
    s_mov_b32 s19, 0x00020000
    s_load_dwordx2 s[16:17], s[0:1], 56
    s_mul_i32 s25, s21, 102400
    s_add_u32 s25, s25, 29380608
    s_lshl_b32 s27, s23, 11
    s_add_u32 s25, s25, s42
    s_add_u32 s27, s27, 12288
Hb_block_kernel_1:
    s_cbranch_execz Hb_block_kernel_2
    v_add_u32 v9, 4096, v8
    s_mul_i32 s28, s23, 3072
    s_add_u32 s24, s24, s28
    s_add_u32 s24, s24, 43008
    s_add_u32 s44, s41, 163840
    s_setprio 0
    s_barrier
    s_add_u32 m0, s42, 122880
    s_nop 0
    buffer_load_dwordx4 v8, s[12:15], s25 offen sc1 lds
    buffer_load_dwordx4 v8, s[12:15], s25 offen offset:1024 sc1 lds
    buffer_load_dwordx4 v8, s[12:15], s25 offen offset:2048 sc1 lds
    buffer_load_dwordx4 v8, s[12:15], s25 offen offset:3072 sc1 lds
    s_add_u32 m0, s42, 126976
    s_nop 0
    buffer_load_dwordx4 v9, s[12:15], s25 offen sc1 lds
    s_addk_i32 s25, 20480
    s_add_u32 m0, s42, 143360
    s_nop 0
    buffer_load_dwordx4 v8, s[12:15], s25 offen sc1 lds
    buffer_load_dwordx4 v8, s[12:15], s25 offen offset:1024 sc1 lds
    buffer_load_dwordx4 v8, s[12:15], s25 offen offset:2048 sc1 lds
    buffer_load_dwordx4 v8, s[12:15], s25 offen offset:3072 sc1 lds
    s_add_u32 m0, s42, 147456
    s_nop 0
    buffer_load_dwordx4 v9, s[12:15], s25 offen sc1 lds
    s_addk_i32 s25, 20480
    s_add_u32 m0, s28, 61440
    s_nop 0
    buffer_load_dwordx4 v8, s[12:15], s24 offen sc1 lds
    buffer_load_dwordx4 v8, s[12:15], s24 offen offset:1024 sc1 lds
    buffer_load_dwordx4 v8, s[12:15], s24 offen offset:2048 sc1 lds
    s_addk_i32 s24, 12288
    s_add_u32 m0, s28, 81920
    s_nop 0
    buffer_load_dwordx4 v8, s[12:15], s24 offen sc1 lds
    buffer_load_dwordx4 v8, s[12:15], s24 offen offset:1024 sc1 lds
    buffer_load_dwordx4 v8, s[12:15], s24 offen offset:2048 sc1 lds
    s_addk_i32 s24, 12288
    s_barrier
    s_waitcnt vmcnt(6) lgkmcnt(0)
    s_barrier
    buffer_load_dwordx4 v[120:123], v8, s[12:15], s44 offen sc1
    buffer_load_dwordx4 v[124:127], v8, s[12:15], s44 offen offset:1024 sc1
    buffer_load_dwordx4 v[128:131], v8, s[12:15], s44 offen offset:2048 sc1
    buffer_load_dwordx4 v[132:135], v8, s[12:15], s44 offen offset:3072 sc1
    buffer_load_dwordx4 v[136:139], v9, s[12:15], s44 offen sc1
    s_addk_i32 s44, 20480
    buffer_load_dwordx4 v[140:143], v8, s[12:15], s44 offen sc1
    buffer_load_dwordx4 v[144:147], v8, s[12:15], s44 offen offset:1024 sc1
    buffer_load_dwordx4 v[148:151], v8, s[12:15], s44 offen offset:2048 sc1
    buffer_load_dwordx4 v[152:155], v8, s[12:15], s44 offen offset:3072 sc1
    buffer_load_dwordx4 v[156:159], v9, s[12:15], s44 offen sc1
    s_addk_i32 s44, 20480
    s_barrier
    s_add_u32 m0, s28, 102400
    s_nop 0
    buffer_load_dwordx4 v8, s[12:15], s24 offen sc1 lds
    buffer_load_dwordx4 v8, s[12:15], s24 offen offset:1024 sc1 lds
    buffer_load_dwordx4 v8, s[12:15], s24 offen offset:2048 sc1 lds
    s_addk_i32 s24, 12288
    s_add_u32 m0, s28, 122880
    s_nop 0
    buffer_load_dwordx4 v8, s[12:15], s24 offen sc1 lds
    buffer_load_dwordx4 v8, s[12:15], s24 offen offset:1024 sc1 lds
    buffer_load_dwordx4 v8, s[12:15], s24 offen offset:2048 sc1 lds
    s_addk_i32 s24, 12288
    s_add_u32 m0, s28, 143360
    s_nop 0
    buffer_load_dwordx4 v8, s[12:15], s24 offen sc1 lds
    buffer_load_dwordx4 v8, s[12:15], s24 offen offset:1024 sc1 lds
    buffer_load_dwordx4 v8, s[12:15], s24 offen offset:2048 sc1 lds
    s_addk_i32 s24, 12288
    s_lshl_b32 s25, s48, 2
    s_add_u32 s25, s25, s23
    s_mul_i32 s25, s25, 40960
    s_add_u32 s25, s25, 16777216
    v_add_u32 v10, 19456, v8
    v_mul_u32_u24 v13, 1280, v3
    v_lshl_add_u32 v12, v4, 4, v13
    v_lshl_add_u32 v13, v4, 3, v13
    v_lshrrev_b32 v1, 1, v4
    v_and_b32 v5, 1, v4
    v_lshlrev_b32 v14, 4, v3
    v_lshl_add_u32 v14, v1, 8, v14
    v_lshl_add_u32 v14, v5, 3, v14
    s_mul_i32 s34, s20, 20480
    s_mul_i32 s35, s21, 2560
    s_mul_i32 s29, s20, 20480
    s_add_u32 s35, s35, s29
    s_add_u32 s35, s35, 16777216
    s_mul_i32 s29, s21, 160
    s_add_u32 s34, s34, s29
    s_barrier
    s_waitcnt vmcnt(0)
    s_barrier
    s_add_u32 m0, s27, 0
    s_nop 0
    buffer_load_dwordx4 v8, s[12:15], s25 offen sc1 lds
    buffer_load_dwordx4 v10, s[12:15], s25 offen offset:1024 sc1 lds
    s_addk_i32 s25, 1024
    s_add_u32 m0, s27, 20480
    s_nop 0
    buffer_load_dwordx4 v8, s[12:15], s25 offen sc1 lds
    buffer_load_dwordx4 v10, s[12:15], s25 offen offset:1024 sc1 lds
    s_addk_i32 s25, 1024
    s_add_u32 m0, s27, 40960
    s_nop 0
    buffer_load_dwordx4 v8, s[12:15], s25 offen sc1 lds
    buffer_load_dwordx4 v10, s[12:15], s25 offen offset:1024 sc1 lds
    s_addk_i32 s25, 1024
    s_add_u32 m0, s27, 61440
    s_nop 0
    buffer_load_dwordx4 v8, s[12:15], s25 offen sc1 lds
    buffer_load_dwordx4 v10, s[12:15], s25 offen offset:1024 sc1 lds
    s_addk_i32 s25, 1024
    s_add_u32 m0, s27, 81920
    s_nop 0
    buffer_load_dwordx4 v8, s[12:15], s25 offen sc1 lds
    buffer_load_dwordx4 v10, s[12:15], s25 offen offset:1024 sc1 lds
    s_addk_i32 s25, 1024
    s_add_u32 m0, s27, 102400
    s_nop 0
    buffer_load_dwordx4 v8, s[12:15], s25 offen sc1 lds
    buffer_load_dwordx4 v10, s[12:15], s25 offen offset:1024 sc1 lds
    s_addk_i32 s25, 1024
    s_add_u32 m0, s27, 122880
    s_nop 0
    buffer_load_dwordx4 v8, s[12:15], s25 offen sc1 lds
    buffer_load_dwordx4 v10, s[12:15], s25 offen offset:1024 sc1 lds
    s_addk_i32 s25, 1024
    s_add_u32 m0, s27, 143360
    s_nop 0
    buffer_load_dwordx4 v8, s[12:15], s25 offen sc1 lds
    buffer_load_dwordx4 v10, s[12:15], s25 offen offset:1024 sc1 lds
    s_addk_i32 s25, 1024
    s_waitcnt vmcnt(14)
    s_barrier
    s_waitcnt vmcnt(12)
    s_barrier
    s_add_u32 m0, s27, 0
    s_nop 0
    buffer_load_dwordx4 v8, s[12:15], s25 offen sc1 lds
    buffer_load_dwordx4 v10, s[12:15], s25 offen offset:1024 sc1 lds
    s_addk_i32 s25, 1024
    s_add_u32 m0, s28, 0
    s_nop 0
    buffer_load_dwordx4 v8, s[12:15], s24 offen sc1 lds
    buffer_load_dwordx4 v8, s[12:15], s24 offen offset:1024 sc1 lds
    buffer_load_dwordx4 v8, s[12:15], s24 offen offset:2048 sc1 lds
    s_addk_i32 s24, 12288
    s_waitcnt vmcnt(15)
    s_barrier
    s_add_u32 m0, s27, 20480
    s_nop 0
    buffer_load_dwordx4 v8, s[12:15], s25 offen sc1 lds
    buffer_load_dwordx4 v10, s[12:15], s25 offen offset:1024 sc1 lds
    s_addk_i32 s25, 1024
    s_add_u32 m0, s28, 20480
    s_nop 0
    buffer_load_dwordx4 v8, s[12:15], s24 offen sc1 lds
Hb_block_kernel_2:
    s_cbranch_execz Hb_block_kernel_3
    buffer_load_dwordx4 v8, s[12:15], s24 offen offset:1024 sc1 lds
    buffer_load_dwordx4 v8, s[12:15], s24 offen offset:2048 sc1 lds
    s_addk_i32 s24, 12288
    s_waitcnt vmcnt(18)
    s_barrier
    s_add_u32 m0, s27, 40960
    s_nop 0
    buffer_load_dwordx4 v8, s[12:15], s25 offen sc1 lds
    buffer_load_dwordx4 v10, s[12:15], s25 offen offset:1024 sc1 lds
    s_addk_i32 s25, 1024
    s_add_u32 m0, s28, 40960
    s_nop 0
    buffer_load_dwordx4 v8, s[12:15], s24 offen sc1 lds
    buffer_load_dwordx4 v8, s[12:15], s24 offen offset:1024 sc1 lds
    buffer_load_dwordx4 v8, s[12:15], s24 offen offset:2048 sc1 lds
    s_addk_i32 s24, 12288
    s_waitcnt vmcnt(21)
    s_barrier
    s_add_u32 m0, s27, 61440
    s_nop 0
    buffer_load_dwordx4 v8, s[12:15], s25 offen sc1 lds
    buffer_load_dwordx4 v10, s[12:15], s25 offen offset:1024 sc1 lds
    s_addk_i32 s25, 1024
    s_add_u32 m0, s28, 61440
    s_nop 0
    buffer_load_dwordx4 v8, s[12:15], s24 offen sc1 lds
    buffer_load_dwordx4 v8, s[12:15], s24 offen offset:1024 sc1 lds
    buffer_load_dwordx4 v8, s[12:15], s24 offen offset:2048 sc1 lds
    s_addk_i32 s24, 12288
    s_waitcnt vmcnt(24)
    s_barrier
    s_add_u32 m0, s27, 81920
    s_nop 0
    buffer_load_dwordx4 v8, s[12:15], s25 offen sc1 lds
    buffer_load_dwordx4 v10, s[12:15], s25 offen offset:1024 sc1 lds
    s_addk_i32 s25, 1024
    s_add_u32 m0, s28, 81920
    s_nop 0
    buffer_load_dwordx4 v8, s[12:15], s24 offen sc1 lds
    buffer_load_dwordx4 v8, s[12:15], s24 offen offset:1024 sc1 lds
    buffer_load_dwordx4 v8, s[12:15], s24 offen offset:2048 sc1 lds
    s_addk_i32 s24, 12288
    s_waitcnt vmcnt(27)
    s_barrier
    s_add_u32 m0, s27, 102400
    s_nop 0
    buffer_load_dwordx4 v8, s[12:15], s25 offen sc1 lds
    buffer_load_dwordx4 v10, s[12:15], s25 offen offset:1024 sc1 lds
    s_addk_i32 s25, 1024
    s_add_u32 m0, s28, 102400
    s_nop 0
    buffer_load_dwordx4 v8, s[12:15], s24 offen sc1 lds
    buffer_load_dwordx4 v8, s[12:15], s24 offen offset:1024 sc1 lds
    buffer_load_dwordx4 v8, s[12:15], s24 offen offset:2048 sc1 lds
    s_addk_i32 s24, 12288
    s_waitcnt vmcnt(30)
    s_barrier
    s_add_u32 m0, s27, 122880
    s_nop 0
    buffer_load_dwordx4 v8, s[12:15], s25 offen sc1 lds
    buffer_load_dwordx4 v10, s[12:15], s25 offen offset:1024 sc1 lds
    s_addk_i32 s25, 1024
    s_add_u32 m0, s28, 122880
    s_nop 0
    buffer_load_dwordx4 v8, s[12:15], s24 offen sc1 lds
    buffer_load_dwordx4 v8, s[12:15], s24 offen offset:1024 sc1 lds
    buffer_load_dwordx4 v8, s[12:15], s24 offen offset:2048 sc1 lds
    s_addk_i32 s24, 12288
    s_waitcnt vmcnt(30)
    s_barrier
    s_add_u32 m0, s27, 143360
    s_nop 0
    buffer_load_dwordx4 v8, s[12:15], s25 offen sc1 lds
    buffer_load_dwordx4 v10, s[12:15], s25 offen offset:1024 sc1 lds
    s_addk_i32 s25, 1024
    s_add_u32 m0, s28, 143360
    s_nop 0
    buffer_load_dwordx4 v8, s[12:15], s24 offen sc1 lds
    buffer_load_dwordx4 v8, s[12:15], s24 offen offset:1024 sc1 lds
    buffer_load_dwordx4 v8, s[12:15], s24 offen offset:2048 sc1 lds
    s_addk_i32 s24, 12288
    s_waitcnt vmcnt(30)
    s_barrier
    s_add_u32 m0, s27, 0
    s_nop 0
    buffer_load_dwordx4 v8, s[12:15], s25 offen sc1 lds
    buffer_load_dwordx4 v10, s[12:15], s25 offen offset:1024 sc1 lds
    s_addk_i32 s25, 1024
    s_add_u32 m0, s28, 0
    s_nop 0
    buffer_load_dwordx4 v8, s[12:15], s24 offen sc1 lds
    buffer_load_dwordx4 v8, s[12:15], s24 offen offset:1024 sc1 lds
    buffer_load_dwordx4 v8, s[12:15], s24 offen offset:2048 sc1 lds
    s_addk_i32 s24, 12288
    s_waitcnt vmcnt(30)
    s_barrier
    s_add_u32 m0, s27, 20480
    s_nop 0
    buffer_load_dwordx4 v8, s[12:15], s25 offen sc1 lds
    buffer_load_dwordx4 v10, s[12:15], s25 offen offset:1024 sc1 lds
    s_addk_i32 s25, 1024
    s_add_u32 m0, s28, 20480
    s_nop 0
    buffer_load_dwordx4 v8, s[12:15], s24 offen sc1 lds
    buffer_load_dwordx4 v8, s[12:15], s24 offen offset:1024 sc1 lds
    buffer_load_dwordx4 v8, s[12:15], s24 offen offset:2048 sc1 lds
    s_addk_i32 s24, 12288
    s_waitcnt vmcnt(30)
    s_barrier
    s_add_u32 m0, s27, 40960
    s_nop 0
    buffer_load_dwordx4 v8, s[12:15], s25 offen sc1 lds
    buffer_load_dwordx4 v10, s[12:15], s25 offen offset:1024 sc1 lds
    s_addk_i32 s25, 1024
    s_add_u32 m0, s28, 40960
    s_nop 0
    buffer_load_dwordx4 v8, s[12:15], s24 offen sc1 lds
    buffer_load_dwordx4 v8, s[12:15], s24 offen offset:1024 sc1 lds
    buffer_load_dwordx4 v8, s[12:15], s24 offen offset:2048 sc1 lds
    s_addk_i32 s24, 12288
    s_waitcnt vmcnt(30)
    s_barrier
    s_add_u32 m0, s27, 61440
    s_nop 0
    buffer_load_dwordx4 v8, s[12:15], s25 offen sc1 lds
    buffer_load_dwordx4 v10, s[12:15], s25 offen offset:1024 sc1 lds
    s_addk_i32 s25, 1024
    s_add_u32 m0, s28, 61440
    s_nop 0
    buffer_load_dwordx4 v8, s[12:15], s24 offen sc1 lds
    buffer_load_dwordx4 v8, s[12:15], s24 offen offset:1024 sc1 lds
    buffer_load_dwordx4 v8, s[12:15], s24 offen offset:2048 sc1 lds
    s_addk_i32 s24, 12288
    s_waitcnt vmcnt(30)
    s_barrier
    s_add_u32 m0, s42, 81920
    s_nop 0
    buffer_load_dwordx4 v8, s[12:15], s41 offen sc1 lds
    buffer_load_dwordx4 v8, s[12:15], s41 offen offset:1024 sc1 lds
    buffer_load_dwordx4 v8, s[12:15], s41 offen offset:2048 sc1 lds
    buffer_load_dwordx4 v8, s[12:15], s41 offen offset:3072 sc1 lds
    s_add_u32 m0, s42, 86016
    s_nop 0
    buffer_load_dwordx4 v9, s[12:15], s41 offen sc1 lds
    s_addk_i32 s41, 20480
    s_waitcnt vmcnt(30)
    s_barrier
    s_add_u32 m0, s42, 102400
    s_nop 0
    buffer_load_dwordx4 v8, s[12:15], s41 offen sc1 lds
    buffer_load_dwordx4 v8, s[12:15], s41 offen offset:1024 sc1 lds
    buffer_load_dwordx4 v8, s[12:15], s41 offen offset:2048 sc1 lds
    buffer_load_dwordx4 v8, s[12:15], s41 offen offset:3072 sc1 lds
    s_add_u32 m0, s42, 106496
    s_nop 0
    buffer_load_dwordx4 v9, s[12:15], s41 offen sc1 lds
    s_addk_i32 s41, 20480
    s_waitcnt vmcnt(30)
    s_barrier
    s_add_u32 m0, s42, 122880
    s_nop 0
    buffer_load_dwordx4 v8, s[12:15], s41 offen sc1 lds
    buffer_load_dwordx4 v8, s[12:15], s41 offen offset:1024 sc1 lds
    buffer_load_dwordx4 v8, s[12:15], s41 offen offset:2048 sc1 lds
    buffer_load_dwordx4 v8, s[12:15], s41 offen offset:3072 sc1 lds
Hb_block_kernel_3:
    s_cbranch_execz Hb_block_kernel_4
    s_add_u32 m0, s42, 126976
    s_nop 0
    buffer_load_dwordx4 v9, s[12:15], s41 offen sc1 lds
    s_addk_i32 s41, 20480
    s_waitcnt vmcnt(30)
    s_barrier
    s_add_u32 m0, s42, 143360
    s_nop 0
    buffer_load_dwordx4 v8, s[12:15], s41 offen sc1 lds
    buffer_load_dwordx4 v8, s[12:15], s41 offen offset:1024 sc1 lds
    buffer_load_dwordx4 v8, s[12:15], s41 offen offset:2048 sc1 lds
    buffer_load_dwordx4 v8, s[12:15], s41 offen offset:3072 sc1 lds
    s_add_u32 m0, s42, 147456
    s_nop 0
    buffer_load_dwordx4 v9, s[12:15], s41 offen sc1 lds
    s_addk_i32 s41, 20480
    s_waitcnt vmcnt(30)
    s_barrier
    s_waitcnt vmcnt(25)
    s_barrier
    s_waitcnt vmcnt(20)
    s_barrier
    buffer_load_dwordx4 v[246:249], v8, s[12:15], s35 offen sc1
    buffer_load_dwordx4 v[250:253], v8, s[12:15], s35 offen offset:1024 sc1
    buffer_load_dwordx2 v[254:255], v14, s[12:15], s35 offen offset:2048 sc1
    s_sub_u32 s25, s20, s23
    s_mul_i32 s25, s25, 49152
    s_lshl_b32 s27, s23, 10
    s_add_u32 s25, s25, s27
    s_add_u32 s25, s25, 20971520
    v_add_u32 v16, s42, v8
    v_add_u32 v17, 61440, v16
    v_add_u32 v18, 122880, v16
    s_add_u32 s27, s23, 1
    s_and_b32 s27, s27, 3
    s_mul_i32 s27, s27, 49152
    v_add_u32 v15, s27, v8
    s_add_u32 s27, s23, 2
    s_and_b32 s27, s27, 3
    s_mul_i32 s27, s27, 49152
    v_add_u32 v19, s27, v8
    s_add_u32 s27, s23, 3
    s_and_b32 s27, s27, 3
    s_mul_i32 s27, s27, 49152
    v_add_u32 v6, s27, v8
    s_add_u32 s27, s23, 4
    s_and_b32 s27, s27, 3
    s_mul_i32 s27, s27, 49152
    v_add_u32 v7, s27, v8
    s_add_u32 s26, s25, 36864
    s_add_u32 s27, s25, 40960
    s_add_u32 s28, s25, 45056
    v_lshlrev_b32 v11, 8, v2
    s_lshl_b32 s43, s20, 9
    s_add_u32 s43, s43, 38010880
    buffer_load_dwordx4 v[160:163], v8, s[12:15], s44 offen sc1
    buffer_load_dwordx4 v[164:167], v8, s[12:15], s44 offen offset:1024 sc1
    buffer_load_dwordx4 v[168:171], v8, s[12:15], s44 offen offset:2048 sc1
    buffer_load_dwordx4 v[172:175], v8, s[12:15], s44 offen offset:3072 sc1
    buffer_load_dwordx4 v[176:179], v9, s[12:15], s44 offen sc1
    s_addk_i32 s44, 20480
    buffer_load_dwordx4 v[180:183], v8, s[12:15], s44 offen sc1
    buffer_load_dwordx4 v[184:187], v8, s[12:15], s44 offen offset:1024 sc1
    buffer_load_dwordx4 v[188:191], v8, s[12:15], s44 offen offset:2048 sc1
    buffer_load_dwordx4 v[192:195], v8, s[12:15], s44 offen offset:3072 sc1
    buffer_load_dwordx4 v[196:199], v9, s[12:15], s44 offen sc1
    s_addk_i32 s44, 20480
    s_waitcnt vmcnt(13)
    s_barrier
    s_add_u32 m0, s42, 0
    s_nop 0
    buffer_load_dwordx4 v8, s[12:15], s41 offen sc1 lds
    buffer_load_dwordx4 v8, s[12:15], s41 offen offset:1024 sc1 lds
    buffer_load_dwordx4 v8, s[12:15], s41 offen offset:2048 sc1 lds
    buffer_load_dwordx4 v8, s[12:15], s41 offen offset:3072 sc1 lds
    s_add_u32 m0, s42, 4096
    s_nop 0
    buffer_load_dwordx4 v9, s[12:15], s41 offen sc1 lds
    s_addk_i32 s41, 20480
    s_add_u32 m0, s42, 20480
    s_nop 0
    buffer_load_dwordx4 v8, s[12:15], s41 offen sc1 lds
    buffer_load_dwordx4 v8, s[12:15], s41 offen offset:1024 sc1 lds
    buffer_load_dwordx4 v8, s[12:15], s41 offen offset:2048 sc1 lds
    buffer_load_dwordx4 v8, s[12:15], s41 offen offset:3072 sc1 lds
    s_add_u32 m0, s42, 24576
    s_nop 0
    buffer_load_dwordx4 v9, s[12:15], s41 offen sc1 lds
    s_addk_i32 s41, 20480
    s_add_u32 m0, s42, 40960
    s_nop 0
    buffer_load_dwordx4 v8, s[12:15], s41 offen sc1 lds
    buffer_load_dwordx4 v8, s[12:15], s41 offen offset:1024 sc1 lds
    buffer_load_dwordx4 v8, s[12:15], s41 offen offset:2048 sc1 lds
    buffer_load_dwordx4 v8, s[12:15], s41 offen offset:3072 sc1 lds
    s_add_u32 m0, s42, 45056
    s_nop 0
    buffer_load_dwordx4 v9, s[12:15], s41 offen sc1 lds
    s_addk_i32 s41, 20480
    s_add_u32 m0, s42, 61440
    s_nop 0
    buffer_load_dwordx4 v8, s[12:15], s41 offen sc1 lds
    buffer_load_dwordx4 v8, s[12:15], s41 offen offset:1024 sc1 lds
    buffer_load_dwordx4 v8, s[12:15], s41 offen offset:2048 sc1 lds
    buffer_load_dwordx4 v8, s[12:15], s41 offen offset:3072 sc1 lds
    s_add_u32 m0, s42, 65536
    s_nop 0
    buffer_load_dwordx4 v9, s[12:15], s41 offen sc1 lds
    s_addk_i32 s41, 20480
    ds_read_b128 v[100:103], v17 offset:20480
    ds_read_b128 v[104:107], v17 offset:21504
    ds_read_b128 v[108:111], v17 offset:22528
    ds_read_b128 v[112:115], v17 offset:23552
    ds_read_b128 v[116:119], v17 offset:24576
    s_sub_u32 s29, s23, 1
    s_and_b32 s29, s29, 3
    s_mul_i32 s29, s29, 5120
    v_add_u32 v10, s29, v8
    s_sub_u32 s29, s23, 2
    s_and_b32 s29, s29, 3
    s_mul_i32 s29, s29, 5120
    v_add_u32 v14, s29, v8
    s_sub_u32 s29, s23, 3
    s_and_b32 s29, s29, 3
    s_mul_i32 s29, s29, 5120
    v_add_u32 v9, s29, v8
    s_waitcnt vmcnt(30)
    v_lshlrev_b32 v80, 16, v246
    v_and_b32 v81, 0xffff0000, v246
    v_lshlrev_b32 v82, 16, v247
    v_and_b32 v83, 0xffff0000, v247
    v_lshlrev_b32 v84, 16, v248
    v_and_b32 v85, 0xffff0000, v248
    v_lshlrev_b32 v86, 16, v249
    v_and_b32 v87, 0xffff0000, v249
    v_lshlrev_b32 v88, 16, v250
    v_and_b32 v89, 0xffff0000, v250
    v_lshlrev_b32 v90, 16, v251
    v_and_b32 v91, 0xffff0000, v251
    v_lshlrev_b32 v92, 16, v252
    v_and_b32 v93, 0xffff0000, v252
    v_lshlrev_b32 v94, 16, v253
    v_and_b32 v95, 0xffff0000, v253
    v_lshlrev_b32 v96, 16, v254
    v_and_b32 v97, 0xffff0000, v254
    v_lshlrev_b32 v98, 16, v255
    v_and_b32 v99, 0xffff0000, v255
    s_mov_b64 exec, 3
    v_mov_b32 v4, 0
    buffer_atomic_or v4, v11, s[12:15], s43 offen sc0 sc1
    s_movk_i32 s50, 20
L_block_kernel_pd_83:
    s_sub_u32 s50, s50, 1
    s_cbranch_scc0 L_block_kernel_pd_83
    s_movk_i32 s50, 20000
L_block_kernel_poll_80:
    v_mov_b32 v5, 0
    buffer_atomic_or v5, v11, s[12:15], s43 offen sc0 sc1
    s_waitcnt vmcnt(1)
    v_cmp_gt_u32 vcc, 16, v4
    s_cbranch_vccz L_block_kernel_pc_82
    v_mov_b32 v4, 0
    buffer_atomic_or v4, v11, s[12:15], s43 offen sc0 sc1
    s_waitcnt vmcnt(1)
    v_cmp_gt_u32 vcc, 16, v5
    s_cbranch_vccz L_block_kernel_pc_82
    s_sub_u32 s50, s50, 1
    s_cbranch_scc0 L_block_kernel_poll_80
L_block_kernel_pc_82:
    s_mov_b64 exec, -1
L_block_kernel_po_81:
    buffer_load_dwordx4 v[200:203], v15, s[12:15], s25 offen sc1
    buffer_load_dwordx4 v[204:207], v19, s[12:15], s25 offen sc1
    buffer_load_dwordx4 v[208:211], v6, s[12:15], s25 offen sc1
Hb_block_kernel_4:
    s_cbranch_execz Hb_block_kernel_5
    buffer_load_dwordx4 v[212:215], v7, s[12:15], s25 offen sc1
    s_addk_i32 s25, 4096
    buffer_load_dwordx4 v[216:219], v15, s[12:15], s25 offen sc1
    buffer_load_dwordx4 v[220:223], v19, s[12:15], s25 offen sc1
    buffer_load_dwordx4 v[224:227], v6, s[12:15], s25 offen sc1
    buffer_load_dwordx4 v[228:231], v7, s[12:15], s25 offen sc1
    s_addk_i32 s25, 4096
    buffer_load_dwordx4 v[232:235], v15, s[12:15], s25 offen sc1
    buffer_load_dwordx4 v[236:239], v19, s[12:15], s25 offen sc1
    s_waitcnt vmcnt(8)
    s_waitcnt lgkmcnt(4)
    v_mfma_f32_16x16x32_bf16 v[20:23], v[100:103], v[200:203], 0
    buffer_load_dwordx4 v[240:243], v6, s[12:15], s25 offen sc1
    v_mfma_f32_16x16x32_bf16 v[40:43], v[100:103], v[204:207], 0
    s_waitcnt lgkmcnt(3)
    v_mfma_f32_16x16x32_bf16 v[24:27], v[104:107], v[200:203], 0
    buffer_load_dwordx4 v[244:247], v7, s[12:15], s25 offen sc1
    s_addk_i32 s25, 4096
    v_mfma_f32_16x16x32_bf16 v[44:47], v[104:107], v[204:207], 0
    s_waitcnt lgkmcnt(2)
    v_mfma_f32_16x16x32_bf16 v[28:31], v[108:111], v[200:203], 0
    buffer_load_dwordx4 v[248:251], v15, s[12:15], s25 offen sc1
    v_mfma_f32_16x16x32_bf16 v[48:51], v[108:111], v[204:207], 0
    s_waitcnt lgkmcnt(1)
    v_mfma_f32_16x16x32_bf16 v[32:35], v[112:115], v[200:203], 0
    v_mfma_f32_16x16x32_bf16 v[52:55], v[112:115], v[204:207], 0
    s_waitcnt lgkmcnt(0)
    v_mfma_f32_16x16x32_bf16 v[36:39], v[116:119], v[200:203], 0
    v_mfma_f32_16x16x32_bf16 v[56:59], v[116:119], v[204:207], 0
    s_waitcnt vmcnt(9)
    v_mfma_f32_16x16x32_bf16 v[60:63], v[100:103], v[208:211], 0
    buffer_load_dwordx4 v[252:255], v19, s[12:15], s25 offen sc1
    v_mfma_f32_16x16x32_bf16 v[80:83], v[100:103], v[212:215], v[80:83]
    ds_read_b128 v[100:103], v17 offset:40960
    v_mfma_f32_16x16x32_bf16 v[64:67], v[104:107], v[208:211], 0
    buffer_load_dwordx4 v[200:203], v6, s[12:15], s25 offen sc1
    v_mfma_f32_16x16x32_bf16 v[84:87], v[104:107], v[212:215], v[84:87]
    ds_read_b128 v[104:107], v17 offset:41984
    v_mfma_f32_16x16x32_bf16 v[68:71], v[108:111], v[208:211], 0
    buffer_load_dwordx4 v[204:207], v7, s[12:15], s25 offen sc1
    s_addk_i32 s25, 4096
    v_mfma_f32_16x16x32_bf16 v[88:91], v[108:111], v[212:215], v[88:91]
    ds_read_b128 v[108:111], v17 offset:43008
    v_mfma_f32_16x16x32_bf16 v[72:75], v[112:115], v[208:211], 0
    v_mfma_f32_16x16x32_bf16 v[92:95], v[112:115], v[212:215], v[92:95]
    ds_read_b128 v[112:115], v17 offset:44032
    v_mfma_f32_16x16x32_bf16 v[76:79], v[116:119], v[208:211], 0
    v_mfma_f32_16x16x32_bf16 v[96:99], v[116:119], v[212:215], v[96:99]
    ds_read_b128 v[116:119], v17 offset:45056
    s_waitcnt vmcnt(10)
    s_waitcnt lgkmcnt(4)
    v_mfma_f32_16x16x32_bf16 v[20:23], v[100:103], v[216:219], v[20:23]
    v_mfma_f32_16x16x32_bf16 v[40:43], v[100:103], v[220:223], v[40:43]
    s_waitcnt lgkmcnt(3)
    v_mfma_f32_16x16x32_bf16 v[24:27], v[104:107], v[216:219], v[24:27]
    v_mfma_f32_16x16x32_bf16 v[44:47], v[104:107], v[220:223], v[44:47]
    s_waitcnt lgkmcnt(2)
    v_mfma_f32_16x16x32_bf16 v[28:31], v[108:111], v[216:219], v[28:31]
    v_mfma_f32_16x16x32_bf16 v[48:51], v[108:111], v[220:223], v[48:51]
    s_waitcnt lgkmcnt(1)
    v_mfma_f32_16x16x32_bf16 v[32:35], v[112:115], v[216:219], v[32:35]
    v_mfma_f32_16x16x32_bf16 v[52:55], v[112:115], v[220:223], v[52:55]
    s_waitcnt lgkmcnt(0)
    v_mfma_f32_16x16x32_bf16 v[36:39], v[116:119], v[216:219], v[36:39]
    v_mfma_f32_16x16x32_bf16 v[56:59], v[116:119], v[220:223], v[56:59]
    s_waitcnt vmcnt(8)
    v_mfma_f32_16x16x32_bf16 v[60:63], v[100:103], v[224:227], v[60:63]
    v_mfma_f32_16x16x32_bf16 v[80:83], v[100:103], v[228:231], v[80:83]
    ds_read_b128 v[100:103], v18 offset:0
    v_mfma_f32_16x16x32_bf16 v[64:67], v[104:107], v[224:227], v[64:67]
    v_mfma_f32_16x16x32_bf16 v[84:87], v[104:107], v[228:231], v[84:87]
    ds_read_b128 v[104:107], v18 offset:1024
    v_mfma_f32_16x16x32_bf16 v[68:71], v[108:111], v[224:227], v[68:71]
    v_mfma_f32_16x16x32_bf16 v[88:91], v[108:111], v[228:231], v[88:91]
    ds_read_b128 v[108:111], v18 offset:2048
    v_mfma_f32_16x16x32_bf16 v[72:75], v[112:115], v[224:227], v[72:75]
    v_mfma_f32_16x16x32_bf16 v[92:95], v[112:115], v[228:231], v[92:95]
    ds_read_b128 v[112:115], v18 offset:3072
    v_mfma_f32_16x16x32_bf16 v[76:79], v[116:119], v[224:227], v[76:79]
    v_mfma_f32_16x16x32_bf16 v[96:99], v[116:119], v[228:231], v[96:99]
    ds_read_b128 v[116:119], v18 offset:4096
    s_waitcnt vmcnt(6)
    s_barrier
    s_waitcnt lgkmcnt(4)
    v_mfma_f32_16x16x32_bf16 v[20:23], v[100:103], v[232:235], v[20:23]
    buffer_load_dwordx4 v[208:211], v15, s[12:15], s25 offen sc1
    v_mfma_f32_16x16x32_bf16 v[40:43], v[100:103], v[236:239], v[40:43]
    s_waitcnt lgkmcnt(3)
    v_mfma_f32_16x16x32_bf16 v[24:27], v[104:107], v[232:235], v[24:27]
    buffer_load_dwordx4 v[212:215], v19, s[12:15], s25 offen sc1
    v_mfma_f32_16x16x32_bf16 v[44:47], v[104:107], v[236:239], v[44:47]
    s_waitcnt lgkmcnt(2)
    v_mfma_f32_16x16x32_bf16 v[28:31], v[108:111], v[232:235], v[28:31]
    buffer_load_dwordx4 v[216:219], v6, s[12:15], s25 offen sc1
    v_mfma_f32_16x16x32_bf16 v[48:51], v[108:111], v[236:239], v[48:51]
    s_waitcnt lgkmcnt(1)
    v_mfma_f32_16x16x32_bf16 v[32:35], v[112:115], v[232:235], v[32:35]
    v_mfma_f32_16x16x32_bf16 v[52:55], v[112:115], v[236:239], v[52:55]
    s_waitcnt lgkmcnt(0)
    v_mfma_f32_16x16x32_bf16 v[36:39], v[116:119], v[232:235], v[36:39]
    v_mfma_f32_16x16x32_bf16 v[56:59], v[116:119], v[236:239], v[56:59]
    s_waitcnt vmcnt(7)
    v_mfma_f32_16x16x32_bf16 v[60:63], v[100:103], v[240:243], v[60:63]
    buffer_load_dwordx4 v[220:223], v7, s[12:15], s25 offen sc1
    s_addk_i32 s25, 4096
    v_mfma_f32_16x16x32_bf16 v[80:83], v[100:103], v[244:247], v[80:83]
    ds_read_b128 v[100:103], v18 offset:20480
    v_mfma_f32_16x16x32_bf16 v[64:67], v[104:107], v[240:243], v[64:67]
    buffer_load_dwordx4 v[224:227], v15, s[12:15], s25 offen sc1
    v_mfma_f32_16x16x32_bf16 v[84:87], v[104:107], v[244:247], v[84:87]
    ds_read_b128 v[104:107], v18 offset:21504
    v_mfma_f32_16x16x32_bf16 v[68:71], v[108:111], v[240:243], v[68:71]
    buffer_load_dwordx4 v[228:231], v19, s[12:15], s25 offen sc1
    v_mfma_f32_16x16x32_bf16 v[88:91], v[108:111], v[244:247], v[88:91]
    ds_read_b128 v[108:111], v18 offset:22528
    v_mfma_f32_16x16x32_bf16 v[72:75], v[112:115], v[240:243], v[72:75]
    v_mfma_f32_16x16x32_bf16 v[92:95], v[112:115], v[244:247], v[92:95]
    ds_read_b128 v[112:115], v18 offset:23552
    v_mfma_f32_16x16x32_bf16 v[76:79], v[116:119], v[240:243], v[76:79]
    v_mfma_f32_16x16x32_bf16 v[96:99], v[116:119], v[244:247], v[96:99]
    ds_read_b128 v[116:119], v18 offset:24576
    s_waitcnt vmcnt(8)
    s_waitcnt lgkmcnt(4)
    v_mfma_f32_16x16x32_bf16 v[20:23], v[100:103], v[248:251], v[20:23]
    buffer_load_dwordx4 v[232:235], v6, s[12:15], s25 offen sc1
    v_mfma_f32_16x16x32_bf16 v[40:43], v[100:103], v[252:255], v[40:43]
    s_waitcnt lgkmcnt(3)
    v_mfma_f32_16x16x32_bf16 v[24:27], v[104:107], v[248:251], v[24:27]
    buffer_load_dwordx4 v[236:239], v7, s[12:15], s25 offen sc1
    s_addk_i32 s25, 4096
    v_mfma_f32_16x16x32_bf16 v[44:47], v[104:107], v[252:255], v[44:47]
    s_waitcnt lgkmcnt(2)
    v_mfma_f32_16x16x32_bf16 v[28:31], v[108:111], v[248:251], v[28:31]
    buffer_load_dwordx4 v[240:243], v15, s[12:15], s25 offen sc1
    v_mfma_f32_16x16x32_bf16 v[48:51], v[108:111], v[252:255], v[48:51]
    s_waitcnt lgkmcnt(1)
    v_mfma_f32_16x16x32_bf16 v[32:35], v[112:115], v[248:251], v[32:35]
    v_mfma_f32_16x16x32_bf16 v[52:55], v[112:115], v[252:255], v[52:55]
    s_waitcnt lgkmcnt(0)
    v_mfma_f32_16x16x32_bf16 v[36:39], v[116:119], v[248:251], v[36:39]
    v_mfma_f32_16x16x32_bf16 v[56:59], v[116:119], v[252:255], v[56:59]
    s_waitcnt vmcnt(9)
    v_mfma_f32_16x16x32_bf16 v[60:63], v[100:103], v[200:203], v[60:63]
    buffer_load_dwordx4 v[244:247], v19, s[12:15], s25 offen sc1
    v_mfma_f32_16x16x32_bf16 v[80:83], v[100:103], v[204:207], v[80:83]
Hb_block_kernel_5:
    s_cbranch_execz Hb_block_kernel_end
    ds_read_b128 v[100:103], v16 offset:0
    v_mfma_f32_16x16x32_bf16 v[64:67], v[104:107], v[200:203], v[64:67]
    buffer_load_dwordx4 v[248:251], v6, s[12:15], s25 offen sc1
    v_mfma_f32_16x16x32_bf16 v[84:87], v[104:107], v[204:207], v[84:87]
    ds_read_b128 v[104:107], v16 offset:1024
    v_mfma_f32_16x16x32_bf16 v[68:71], v[108:111], v[200:203], v[68:71]
    buffer_load_dwordx4 v[252:255], v7, s[12:15], s25 offen sc1
    s_addk_i32 s25, 4096
    v_mfma_f32_16x16x32_bf16 v[88:91], v[108:111], v[204:207], v[88:91]
    ds_read_b128 v[108:111], v16 offset:2048
    v_mfma_f32_16x16x32_bf16 v[72:75], v[112:115], v[200:203], v[72:75]
    v_mfma_f32_16x16x32_bf16 v[92:95], v[112:115], v[204:207], v[92:95]
    ds_read_b128 v[112:115], v16 offset:3072
    v_mfma_f32_16x16x32_bf16 v[76:79], v[116:119], v[200:203], v[76:79]
    v_mfma_f32_16x16x32_bf16 v[96:99], v[116:119], v[204:207], v[96:99]
    ds_read_b128 v[116:119], v16 offset:4096
    s_waitcnt vmcnt(10)
    s_waitcnt lgkmcnt(4)
    v_mfma_f32_16x16x32_bf16 v[20:23], v[100:103], v[208:211], v[20:23]
    buffer_load_dwordx4 v[200:203], v15, s[12:15], s25 offen sc1
    v_mfma_f32_16x16x32_bf16 v[40:43], v[100:103], v[212:215], v[40:43]
    s_waitcnt lgkmcnt(3)
    v_mfma_f32_16x16x32_bf16 v[24:27], v[104:107], v[208:211], v[24:27]
    buffer_load_dwordx4 v[204:207], v19, s[12:15], s25 offen sc1
    v_mfma_f32_16x16x32_bf16 v[44:47], v[104:107], v[212:215], v[44:47]
    s_waitcnt lgkmcnt(2)
    v_mfma_f32_16x16x32_bf16 v[28:31], v[108:111], v[208:211], v[28:31]
    v_mfma_f32_16x16x32_bf16 v[48:51], v[108:111], v[212:215], v[48:51]
    s_waitcnt lgkmcnt(1)
    v_mfma_f32_16x16x32_bf16 v[32:35], v[112:115], v[208:211], v[32:35]
    v_mfma_f32_16x16x32_bf16 v[52:55], v[112:115], v[212:215], v[52:55]
    s_waitcnt lgkmcnt(0)
    v_mfma_f32_16x16x32_bf16 v[36:39], v[116:119], v[208:211], v[36:39]
    v_mfma_f32_16x16x32_bf16 v[56:59], v[116:119], v[212:215], v[56:59]
    s_waitcnt vmcnt(10)
    v_mfma_f32_16x16x32_bf16 v[60:63], v[100:103], v[216:219], v[60:63]
    buffer_load_dwordx4 v[208:211], v6, s[12:15], s25 offen sc1
    v_mfma_f32_16x16x32_bf16 v[80:83], v[100:103], v[220:223], v[80:83]
    ds_read_b128 v[100:103], v16 offset:20480
    v_mfma_f32_16x16x32_bf16 v[64:67], v[104:107], v[216:219], v[64:67]
    buffer_load_dwordx4 v[212:215], v7, s[12:15], s25 offen sc1
    s_addk_i32 s25, 4096
    v_mfma_f32_16x16x32_bf16 v[84:87], v[104:107], v[220:223], v[84:87]
    ds_read_b128 v[104:107], v16 offset:21504
    v_mfma_f32_16x16x32_bf16 v[68:71], v[108:111], v[216:219], v[68:71]
    v_mfma_f32_16x16x32_bf16 v[88:91], v[108:111], v[220:223], v[88:91]
    ds_read_b128 v[108:111], v16 offset:22528
    v_mfma_f32_16x16x32_bf16 v[72:75], v[112:115], v[216:219], v[72:75]
    v_mfma_f32_16x16x32_bf16 v[92:95], v[112:115], v[220:223], v[92:95]
    ds_read_b128 v[112:115], v16 offset:23552
    v_mfma_f32_16x16x32_bf16 v[76:79], v[116:119], v[216:219], v[76:79]
    v_mfma_f32_16x16x32_bf16 v[96:99], v[116:119], v[220:223], v[96:99]
    ds_read_b128 v[116:119], v16 offset:24576
    s_waitcnt vmcnt(10)
    s_waitcnt lgkmcnt(4)
    v_mfma_f32_16x16x32_bf16 v[20:23], v[100:103], v[224:227], v[20:23]
    buffer_load_dwordx4 v[216:219], v15, s[12:15], s25 offen sc1
    v_mfma_f32_16x16x32_bf16 v[40:43], v[100:103], v[228:231], v[40:43]
    s_waitcnt lgkmcnt(3)
    v_mfma_f32_16x16x32_bf16 v[24:27], v[104:107], v[224:227], v[24:27]
    buffer_load_dwordx4 v[220:223], v15, s[12:15], s26 offen sc1
    v_mfma_f32_16x16x32_bf16 v[44:47], v[104:107], v[228:231], v[44:47]
    s_waitcnt lgkmcnt(2)
    v_mfma_f32_16x16x32_bf16 v[28:31], v[108:111], v[224:227], v[28:31]
    v_mfma_f32_16x16x32_bf16 v[48:51], v[108:111], v[228:231], v[48:51]
    s_waitcnt lgkmcnt(1)
    v_mfma_f32_16x16x32_bf16 v[32:35], v[112:115], v[224:227], v[32:35]
    v_mfma_f32_16x16x32_bf16 v[52:55], v[112:115], v[228:231], v[52:55]
    s_waitcnt lgkmcnt(0)
    v_mfma_f32_16x16x32_bf16 v[36:39], v[116:119], v[224:227], v[36:39]
    v_mfma_f32_16x16x32_bf16 v[56:59], v[116:119], v[228:231], v[56:59]
    s_waitcnt vmcnt(10)
    v_mfma_f32_16x16x32_bf16 v[60:63], v[100:103], v[232:235], v[60:63]
    buffer_load_dwordx4 v[224:227], v15, s[12:15], s27 offen sc1
    v_mfma_f32_16x16x32_bf16 v[80:83], v[100:103], v[236:239], v[80:83]
    ds_read_b128 v[100:103], v16 offset:40960
    v_mfma_f32_16x16x32_bf16 v[64:67], v[104:107], v[232:235], v[64:67]
    buffer_load_dwordx4 v[228:231], v15, s[12:15], s28 offen sc1
    v_mfma_f32_16x16x32_bf16 v[84:87], v[104:107], v[236:239], v[84:87]
    ds_read_b128 v[104:107], v16 offset:41984
    v_mfma_f32_16x16x32_bf16 v[68:71], v[108:111], v[232:235], v[68:71]
    v_mfma_f32_16x16x32_bf16 v[88:91], v[108:111], v[236:239], v[88:91]
    ds_read_b128 v[108:111], v16 offset:43008
    v_mfma_f32_16x16x32_bf16 v[72:75], v[112:115], v[232:235], v[72:75]
    v_mfma_f32_16x16x32_bf16 v[92:95], v[112:115], v[236:239], v[92:95]
    ds_read_b128 v[112:115], v16 offset:44032
    v_mfma_f32_16x16x32_bf16 v[76:79], v[116:119], v[232:235], v[76:79]
    v_mfma_f32_16x16x32_bf16 v[96:99], v[116:119], v[236:239], v[96:99]
    ds_read_b128 v[116:119], v16 offset:45056
    s_waitcnt vmcnt(10)
    s_waitcnt lgkmcnt(4)
    v_mfma_f32_16x16x32_bf16 v[20:23], v[100:103], v[240:243], v[20:23]
    buffer_load_dwordx4 v[232:235], v19, s[12:15], s25 offen sc1
    v_mfma_f32_16x16x32_bf16 v[40:43], v[100:103], v[244:247], v[40:43]
    s_waitcnt lgkmcnt(3)
    v_mfma_f32_16x16x32_bf16 v[24:27], v[104:107], v[240:243], v[24:27]
    buffer_load_dwordx4 v[236:239], v19, s[12:15], s26 offen sc1
    v_mfma_f32_16x16x32_bf16 v[44:47], v[104:107], v[244:247], v[44:47]
    s_waitcnt lgkmcnt(2)
    v_mfma_f32_16x16x32_bf16 v[28:31], v[108:111], v[240:243], v[28:31]
    v_mfma_f32_16x16x32_bf16 v[48:51], v[108:111], v[244:247], v[48:51]
    s_waitcnt lgkmcnt(1)
    v_mfma_f32_16x16x32_bf16 v[32:35], v[112:115], v[240:243], v[32:35]
    v_mfma_f32_16x16x32_bf16 v[52:55], v[112:115], v[244:247], v[52:55]
    s_waitcnt lgkmcnt(0)
    v_mfma_f32_16x16x32_bf16 v[36:39], v[116:119], v[240:243], v[36:39]
    v_mfma_f32_16x16x32_bf16 v[56:59], v[116:119], v[244:247], v[56:59]
    s_waitcnt vmcnt(10)
    v_mfma_f32_16x16x32_bf16 v[60:63], v[100:103], v[248:251], v[60:63]
    buffer_load_dwordx4 v[240:243], v19, s[12:15], s27 offen sc1
    v_mfma_f32_16x16x32_bf16 v[80:83], v[100:103], v[252:255], v[80:83]
    ds_read_b128 v[100:103], v17 offset:0
    v_mfma_f32_16x16x32_bf16 v[64:67], v[104:107], v[248:251], v[64:67]
    buffer_load_dwordx4 v[244:247], v19, s[12:15], s28 offen sc1
    v_mfma_f32_16x16x32_bf16 v[84:87], v[104:107], v[252:255], v[84:87]
    ds_read_b128 v[104:107], v17 offset:1024
    v_mfma_f32_16x16x32_bf16 v[68:71], v[108:111], v[248:251], v[68:71]
    v_mfma_f32_16x16x32_bf16 v[88:91], v[108:111], v[252:255], v[88:91]
    ds_read_b128 v[108:111], v17 offset:2048
    v_mfma_f32_16x16x32_bf16 v[72:75], v[112:115], v[248:251], v[72:75]
    v_mfma_f32_16x16x32_bf16 v[92:95], v[112:115], v[252:255], v[92:95]
    ds_read_b128 v[112:115], v17 offset:3072
    v_mfma_f32_16x16x32_bf16 v[76:79], v[116:119], v[248:251], v[76:79]
    v_mfma_f32_16x16x32_bf16 v[96:99], v[116:119], v[252:255], v[96:99]
    ds_read_b128 v[116:119], v17 offset:4096
    s_waitcnt vmcnt(10)
    s_waitcnt lgkmcnt(4)
    v_mfma_f32_16x16x32_bf16 v[20:23], v[100:103], v[200:203], v[20:23]
    buffer_load_dwordx4 v[248:251], v6, s[12:15], s25 offen sc1
    v_mfma_f32_16x16x32_bf16 v[40:43], v[100:103], v[204:207], v[40:43]
    s_waitcnt lgkmcnt(3)
    v_mfma_f32_16x16x32_bf16 v[24:27], v[104:107], v[200:203], v[24:27]
    buffer_load_dwordx4 v[252:255], v6, s[12:15], s26 offen sc1
    v_mfma_f32_16x16x32_bf16 v[44:47], v[104:107], v[204:207], v[44:47]
    s_waitcnt lgkmcnt(2)
    v_mfma_f32_16x16x32_bf16 v[28:31], v[108:111], v[200:203], v[28:31]
    v_mfma_f32_16x16x32_bf16 v[48:51], v[108:111], v[204:207], v[48:51]
    s_waitcnt lgkmcnt(1)
    v_mfma_f32_16x16x32_bf16 v[32:35], v[112:115], v[200:203], v[32:35]
    v_mfma_f32_16x16x32_bf16 v[52:55], v[112:115], v[204:207], v[52:55]
    s_waitcnt lgkmcnt(0)
    v_mfma_f32_16x16x32_bf16 v[36:39], v[116:119], v[200:203], v[36:39]
Hb_block_kernel_seg1:
Hb_block_kernel_seg2:
Hb_block_kernel_6:
    s_cbranch_execz Hb_block_kernel_7
    v_mfma_f32_16x16x32_bf16 v[56:59], v[116:119], v[204:207], v[56:59]
    s_waitcnt vmcnt(10)
    v_mfma_f32_16x16x32_bf16 v[60:63], v[100:103], v[208:211], v[60:63]
    buffer_load_dwordx4 v[200:203], v6, s[12:15], s27 offen sc1
    v_mfma_f32_16x16x32_bf16 v[80:83], v[100:103], v[212:215], v[80:83]
    v_mfma_f32_16x16x32_bf16 v[64:67], v[104:107], v[208:211], v[64:67]
    buffer_load_dwordx4 v[204:207], v6, s[12:15], s28 offen sc1
    v_mfma_f32_16x16x32_bf16 v[84:87], v[104:107], v[212:215], v[84:87]
    v_mfma_f32_16x16x32_bf16 v[68:71], v[108:111], v[208:211], v[68:71]
    buffer_load_dwordx4 v[100:103], v7, s[12:15], s25 offen sc1
    v_mfma_f32_16x16x32_bf16 v[88:91], v[108:111], v[212:215], v[88:91]
    v_mfma_f32_16x16x32_bf16 v[72:75], v[112:115], v[208:211], v[72:75]
    v_mfma_f32_16x16x32_bf16 v[92:95], v[112:115], v[212:215], v[92:95]
    v_mfma_f32_16x16x32_bf16 v[76:79], v[116:119], v[208:211], v[76:79]
    v_mfma_f32_16x16x32_bf16 v[96:99], v[116:119], v[212:215], v[96:99]
    s_waitcnt vmcnt(12)
    v_mfma_f32_16x16x32_bf16 v[20:23], v[120:123], v[216:219], v[20:23]
    buffer_load_dwordx4 v[104:107], v7, s[12:15], s26 offen sc1
    v_mfma_f32_16x16x32_bf16 v[24:27], v[124:127], v[216:219], v[24:27]
    buffer_load_dwordx4 v[108:111], v7, s[12:15], s27 offen sc1
    v_mfma_f32_16x16x32_bf16 v[28:31], v[128:131], v[216:219], v[28:31]
    v_mfma_f32_16x16x32_bf16 v[32:35], v[132:135], v[216:219], v[32:35]
    v_mfma_f32_16x16x32_bf16 v[36:39], v[136:139], v[216:219], v[36:39]
    s_waitcnt vmcnt(13)
    v_mfma_f32_16x16x32_bf16 v[20:23], v[140:143], v[220:223], v[20:23]
    buffer_load_dwordx4 v[112:115], v7, s[12:15], s28 offen sc1
    v_mfma_f32_16x16x32_bf16 v[24:27], v[144:147], v[220:223], v[24:27]
    v_mfma_f32_16x16x32_bf16 v[28:31], v[148:151], v[220:223], v[28:31]
    v_mfma_f32_16x16x32_bf16 v[32:35], v[152:155], v[220:223], v[32:35]
    v_mfma_f32_16x16x32_bf16 v[36:39], v[156:159], v[220:223], v[36:39]
    s_waitcnt vmcnt(13)
    v_mfma_f32_16x16x32_bf16 v[20:23], v[160:163], v[224:227], v[20:23]
    v_mfma_f32_16x16x32_bf16 v[24:27], v[164:167], v[224:227], v[24:27]
    v_mfma_f32_16x16x32_bf16 v[28:31], v[168:171], v[224:227], v[28:31]
    v_mfma_f32_16x16x32_bf16 v[32:35], v[172:175], v[224:227], v[32:35]
    v_mfma_f32_16x16x32_bf16 v[36:39], v[176:179], v[224:227], v[36:39]
    s_waitcnt vmcnt(12)
    v_mfma_f32_16x16x32_bf16 v[20:23], v[180:183], v[228:231], v[20:23]
    v_mfma_f32_16x16x32_bf16 v[24:27], v[184:187], v[228:231], v[24:27]
    v_mfma_f32_16x16x32_bf16 v[28:31], v[188:191], v[228:231], v[28:31]
    v_mfma_f32_16x16x32_bf16 v[32:35], v[192:195], v[228:231], v[32:35]
    v_mfma_f32_16x16x32_bf16 v[36:39], v[196:199], v[228:231], v[36:39]
    s_waitcnt vmcnt(11)
    v_mfma_f32_16x16x32_bf16 v[40:43], v[120:123], v[232:235], v[40:43]
    v_mfma_f32_16x16x32_bf16 v[44:47], v[124:127], v[232:235], v[44:47]
    s_nop 0
    ds_write_b128 v16, v[20:23] offset:0
    v_mfma_f32_16x16x32_bf16 v[48:51], v[128:131], v[232:235], v[48:51]
    v_mfma_f32_16x16x32_bf16 v[52:55], v[132:135], v[232:235], v[52:55]
    ds_write_b128 v16, v[24:27] offset:1024
    v_mfma_f32_16x16x32_bf16 v[56:59], v[136:139], v[232:235], v[56:59]
    s_waitcnt vmcnt(10)
    v_mfma_f32_16x16x32_bf16 v[40:43], v[140:143], v[236:239], v[40:43]
    ds_write_b128 v16, v[28:31] offset:2048
    v_mfma_f32_16x16x32_bf16 v[44:47], v[144:147], v[236:239], v[44:47]
    v_mfma_f32_16x16x32_bf16 v[48:51], v[148:151], v[236:239], v[48:51]
    ds_write_b128 v16, v[32:35] offset:3072
    v_mfma_f32_16x16x32_bf16 v[52:55], v[152:155], v[236:239], v[52:55]
    v_mfma_f32_16x16x32_bf16 v[56:59], v[156:159], v[236:239], v[56:59]
    ds_write_b128 v16, v[36:39] offset:4096
    s_waitcnt vmcnt(9)
    v_mfma_f32_16x16x32_bf16 v[40:43], v[160:163], v[240:243], v[40:43]
    v_mfma_f32_16x16x32_bf16 v[44:47], v[164:167], v[240:243], v[44:47]
    v_mfma_f32_16x16x32_bf16 v[48:51], v[168:171], v[240:243], v[48:51]
    v_mfma_f32_16x16x32_bf16 v[52:55], v[172:175], v[240:243], v[52:55]
    v_mfma_f32_16x16x32_bf16 v[56:59], v[176:179], v[240:243], v[56:59]
    s_waitcnt vmcnt(8)
    v_mfma_f32_16x16x32_bf16 v[40:43], v[180:183], v[244:247], v[40:43]
    v_mfma_f32_16x16x32_bf16 v[44:47], v[184:187], v[244:247], v[44:47]
    v_mfma_f32_16x16x32_bf16 v[48:51], v[188:191], v[244:247], v[48:51]
    v_mfma_f32_16x16x32_bf16 v[52:55], v[192:195], v[244:247], v[52:55]
    v_mfma_f32_16x16x32_bf16 v[56:59], v[196:199], v[244:247], v[56:59]
    s_waitcnt vmcnt(7)
    v_mfma_f32_16x16x32_bf16 v[60:63], v[120:123], v[248:251], v[60:63]
    v_mfma_f32_16x16x32_bf16 v[64:67], v[124:127], v[248:251], v[64:67]
    s_nop 0
    ds_write_b128 v16, v[40:43] offset:20480
    v_mfma_f32_16x16x32_bf16 v[68:71], v[128:131], v[248:251], v[68:71]
    v_mfma_f32_16x16x32_bf16 v[72:75], v[132:135], v[248:251], v[72:75]
    ds_write_b128 v16, v[44:47] offset:21504
    v_mfma_f32_16x16x32_bf16 v[76:79], v[136:139], v[248:251], v[76:79]
    s_waitcnt vmcnt(6)
    v_mfma_f32_16x16x32_bf16 v[60:63], v[140:143], v[252:255], v[60:63]
    ds_write_b128 v16, v[48:51] offset:22528
    v_mfma_f32_16x16x32_bf16 v[64:67], v[144:147], v[252:255], v[64:67]
    v_mfma_f32_16x16x32_bf16 v[68:71], v[148:151], v[252:255], v[68:71]
    ds_write_b128 v16, v[52:55] offset:23552
    v_mfma_f32_16x16x32_bf16 v[72:75], v[152:155], v[252:255], v[72:75]
    v_mfma_f32_16x16x32_bf16 v[76:79], v[156:159], v[252:255], v[76:79]
    ds_write_b128 v16, v[56:59] offset:24576
    s_waitcnt vmcnt(5)
    v_mfma_f32_16x16x32_bf16 v[60:63], v[160:163], v[200:203], v[60:63]
    v_mfma_f32_16x16x32_bf16 v[64:67], v[164:167], v[200:203], v[64:67]
    v_mfma_f32_16x16x32_bf16 v[68:71], v[168:171], v[200:203], v[68:71]
    v_mfma_f32_16x16x32_bf16 v[72:75], v[172:175], v[200:203], v[72:75]
    v_mfma_f32_16x16x32_bf16 v[76:79], v[176:179], v[200:203], v[76:79]
    s_waitcnt lgkmcnt(0)
    s_barrier
    ds_read_b128 v[20:23], v10 offset:0
    ds_read_b128 v[40:43], v14 offset:20480
    s_waitcnt vmcnt(4)
    v_mfma_f32_16x16x32_bf16 v[60:63], v[180:183], v[204:207], v[60:63]
    ds_read_b128 v[24:27], v10 offset:1024
    ds_read_b128 v[44:47], v14 offset:21504
    v_mfma_f32_16x16x32_bf16 v[64:67], v[184:187], v[204:207], v[64:67]
    ds_read_b128 v[28:31], v10 offset:2048
    ds_read_b128 v[48:51], v14 offset:22528
    v_mfma_f32_16x16x32_bf16 v[68:71], v[188:191], v[204:207], v[68:71]
    ds_read_b128 v[32:35], v10 offset:3072
    ds_read_b128 v[52:55], v14 offset:23552
    v_mfma_f32_16x16x32_bf16 v[72:75], v[192:195], v[204:207], v[72:75]
    ds_read_b128 v[36:39], v10 offset:4096
    ds_read_b128 v[56:59], v14 offset:24576
    v_mfma_f32_16x16x32_bf16 v[76:79], v[196:199], v[204:207], v[76:79]
    s_waitcnt vmcnt(3)
    v_mfma_f32_16x16x32_bf16 v[80:83], v[120:123], v[100:103], v[80:83]
    v_mfma_f32_16x16x32_bf16 v[84:87], v[124:127], v[100:103], v[84:87]
    ds_write_b128 v16, v[60:63] offset:40960
    v_mfma_f32_16x16x32_bf16 v[88:91], v[128:131], v[100:103], v[88:91]
    ds_write_b128 v16, v[64:67] offset:41984
    v_mfma_f32_16x16x32_bf16 v[92:95], v[132:135], v[100:103], v[92:95]
    ds_write_b128 v16, v[68:71] offset:43008
    v_mfma_f32_16x16x32_bf16 v[96:99], v[136:139], v[100:103], v[96:99]
    ds_write_b128 v16, v[72:75] offset:44032
    s_waitcnt vmcnt(2)
    v_mfma_f32_16x16x32_bf16 v[80:83], v[140:143], v[104:107], v[80:83]
    ds_write_b128 v16, v[76:79] offset:45056
    v_mfma_f32_16x16x32_bf16 v[84:87], v[144:147], v[104:107], v[84:87]
    v_mfma_f32_16x16x32_bf16 v[88:91], v[148:151], v[104:107], v[88:91]
    v_mfma_f32_16x16x32_bf16 v[92:95], v[152:155], v[104:107], v[92:95]
    v_mfma_f32_16x16x32_bf16 v[96:99], v[156:159], v[104:107], v[96:99]
    s_waitcnt lgkmcnt(0)
    s_barrier
    ds_read_b128 v[60:63], v9 offset:40960
    ds_read_b128 v[64:67], v9 offset:41984
    s_waitcnt vmcnt(1)
    v_mfma_f32_16x16x32_bf16 v[80:83], v[160:163], v[108:111], v[80:83]
    ds_read_b128 v[68:71], v9 offset:43008
    ds_read_b128 v[72:75], v9 offset:44032
Hb_block_kernel_7:
    s_cbranch_execz Hb_block_kernel_8
    v_pk_add_f32 v[20:21], v[20:21], v[40:41]
    v_pk_add_f32 v[22:23], v[22:23], v[42:43]
    v_mfma_f32_16x16x32_bf16 v[84:87], v[164:167], v[108:111], v[84:87]
    ds_read_b128 v[76:79], v9 offset:45056
    v_pk_add_f32 v[24:25], v[24:25], v[44:45]
    v_pk_add_f32 v[26:27], v[26:27], v[46:47]
    v_mfma_f32_16x16x32_bf16 v[88:91], v[168:171], v[108:111], v[88:91]
    v_pk_add_f32 v[28:29], v[28:29], v[48:49]
    v_pk_add_f32 v[30:31], v[30:31], v[50:51]
    v_mfma_f32_16x16x32_bf16 v[92:95], v[172:175], v[108:111], v[92:95]
    v_pk_add_f32 v[32:33], v[32:33], v[52:53]
    v_pk_add_f32 v[34:35], v[34:35], v[54:55]
    v_mfma_f32_16x16x32_bf16 v[96:99], v[176:179], v[108:111], v[96:99]
    v_pk_add_f32 v[36:37], v[36:37], v[56:57]
    v_pk_add_f32 v[38:39], v[38:39], v[58:59]
    s_waitcnt vmcnt(0)
    v_mfma_f32_16x16x32_bf16 v[80:83], v[180:183], v[112:115], v[80:83]
    s_waitcnt lgkmcnt(4)
    v_pk_add_f32 v[20:21], v[20:21], v[60:61]
    v_pk_add_f32 v[22:23], v[22:23], v[62:63]
    v_mfma_f32_16x16x32_bf16 v[84:87], v[184:187], v[112:115], v[84:87]
    s_waitcnt lgkmcnt(3)
    v_pk_add_f32 v[24:25], v[24:25], v[64:65]
    v_pk_add_f32 v[26:27], v[26:27], v[66:67]
    v_mfma_f32_16x16x32_bf16 v[88:91], v[188:191], v[112:115], v[88:91]
    s_waitcnt lgkmcnt(2)
    v_pk_add_f32 v[28:29], v[28:29], v[68:69]
    v_pk_add_f32 v[30:31], v[30:31], v[70:71]
    v_mfma_f32_16x16x32_bf16 v[92:95], v[192:195], v[112:115], v[92:95]
    s_waitcnt lgkmcnt(1)
    v_pk_add_f32 v[32:33], v[32:33], v[72:73]
    v_pk_add_f32 v[34:35], v[34:35], v[74:75]
    v_mfma_f32_16x16x32_bf16 v[96:99], v[196:199], v[112:115], v[96:99]
    s_waitcnt lgkmcnt(0)
    v_pk_add_f32 v[36:37], v[36:37], v[76:77]
    v_pk_add_f32 v[38:39], v[38:39], v[78:79]
    v_pk_add_f32 v[80:81], v[80:81], v[20:21]
    v_pk_add_f32 v[82:83], v[82:83], v[22:23]
    v_cvt_pk_bf16_f32 v246, v80, v81
    v_cvt_pk_bf16_f32 v247, v82, v83
    v_pk_add_f32 v[84:85], v[84:85], v[24:25]
    v_pk_add_f32 v[86:87], v[86:87], v[26:27]
    v_cvt_pk_bf16_f32 v248, v84, v85
    v_cvt_pk_bf16_f32 v249, v86, v87
    v_pk_add_f32 v[88:89], v[88:89], v[28:29]
    v_pk_add_f32 v[90:91], v[90:91], v[30:31]
    v_cvt_pk_bf16_f32 v250, v88, v89
    v_cvt_pk_bf16_f32 v251, v90, v91
    v_pk_add_f32 v[92:93], v[92:93], v[32:33]
    v_pk_add_f32 v[94:95], v[94:95], v[34:35]
    v_cvt_pk_bf16_f32 v252, v92, v93
    v_cvt_pk_bf16_f32 v253, v94, v95
    v_pk_add_f32 v[96:97], v[96:97], v[36:37]
    v_pk_add_f32 v[98:99], v[98:99], v[38:39]
    v_cvt_pk_bf16_f32 v254, v96, v97
    v_cvt_pk_bf16_f32 v255, v98, v99
    buffer_store_dwordx4 v[246:249], v12, s[16:19], s34 offen nt
    buffer_store_dwordx4 v[250:253], v12, s[16:19], s34 offen offset:64 nt
    buffer_store_dwordx2 v[254:255], v13, s[16:19], s34 offen offset:128 nt
    s_endpgm
L_block_kernel_lead_76:
    s_load_dwordx2 s[16:17], s[0:1], 0
    s_lshr_b32 s3, s30, 1
    s_lshl1_add_u32 s3, s30, s3
    s_lshl_b32 s3, s3, 9
    s_add_u32 s3, s3, 40960
    v_and_b32 v1, 7, v2
    v_lshl_add_u32 v1, v1, 2, s3
    v_sub_u32 v6, 0, v4
L_block_kernel_pg_84:
    ds_read_b32 v7, v1
    s_sub_u32 s4, s4, 1
    s_cselect_b64 s[6:7], 0, -1
    s_waitcnt lgkmcnt(0)
    v_cmp_gt_u32 vcc, v241, v7
    s_nop 0
    s_and_b64 s[6:7], s[6:7], vcc
    s_cbranch_scc1 L_block_kernel_pg_84
    v_or_b32 v163, v163, v6
    ds_write_b128 v242, v[136:139] offset:0
    ds_write_b128 v242, v[140:143] offset:1024
    ds_write_b128 v242, v[144:147] offset:2048
    ds_write_b128 v242, v[152:155] offset:20480
    ds_write_b128 v242, v[156:159] offset:21504
    ds_write_b128 v242, v[160:163] offset:22528
    s_bfe_u32 s20, s2, 0x20001
    s_bfe_u32 s30, s2, 0x30003
    s_lshl3_add_u32 s20, s20, s30
    s_and_b32 s21, s2, 1
    s_lshr_b32 s31, s2, 6
    s_lshl2_add_u32 s21, s21, s31
    s_lshr_b32 s48, s20, 1
    s_lshl_b32 s49, s21, 1
    s_and_b32 s30, s30, 1
    s_add_u32 s49, s49, s30
    v_lshlrev_b32 v8, 4, v2
    s_and_b32 s23, s22, 3
    s_lshl_b32 s43, s48, 12
    s_add_u32 s43, s43, 37748736
    s_lshl_b32 s20, s20, 2
    s_add_u32 s20, s20, s23
    v_and_b32 v3, 15, v2
    v_lshrrev_b32 v4, 4, v2
    s_mul_i32 s42, s23, 5120
    s_mul_i32 s41, s21, 245760
    s_add_u32 s41, s41, s42
    s_add_u32 s41, s41, 30408704
    s_mul_i32 s24, s49, 251904
    s_add_u32 s24, s24, 33554432
    s_mov_b32 s18, 2621440
    s_mov_b32 s19, 0x00020000
    s_mul_i32 s4, s21, 102400
    s_add_u32 s4, s4, 29360128
    s_add_u32 s5, s4, s42
    v_add_u32 v9, 4096, v8
    s_lshl_b32 s7, s23, 11
    s_add_u32 s6, s4, s7
    s_add_u32 s6, s6, 61440
    s_add_u32 m0, s42, 102400
    s_nop 0
    buffer_load_dwordx4 v8, s[12:15], s5 offen sc1 lds
    buffer_load_dwordx4 v8, s[12:15], s5 offen offset:1024 sc1 lds
    buffer_load_dwordx4 v8, s[12:15], s5 offen offset:2048 sc1 lds
    buffer_load_dwordx4 v8, s[12:15], s5 offen offset:3072 sc1 lds
    s_add_u32 m0, s42, 106496
    s_nop 0
    buffer_load_dwordx4 v9, s[12:15], s5 offen sc1 lds
    s_addk_i32 s5, 20480
    s_add_u32 m0, s7, 12288
    s_nop 0
    buffer_load_dwordx4 v8, s[12:15], s6 offen sc1 lds
    buffer_load_dwordx4 v8, s[12:15], s6 offen offset:1024 sc1 lds
    s_addk_i32 s6, 8192
    s_add_u32 m0, s7, 32768
    s_nop 0
    buffer_load_dwordx4 v8, s[12:15], s6 offen sc1 lds
    buffer_load_dwordx4 v8, s[12:15], s6 offen offset:1024 sc1 lds
    s_addk_i32 s6, 8192
    s_add_u32 m0, s7, 53248
    s_nop 0
    buffer_load_dwordx4 v8, s[12:15], s6 offen sc1 lds
    buffer_load_dwordx4 v8, s[12:15], s6 offen offset:1024 sc1 lds
    s_addk_i32 s6, 8192
    s_add_u32 m0, s7, 73728
    s_nop 0
    buffer_load_dwordx4 v8, s[12:15], s6 offen sc1 lds
    buffer_load_dwordx4 v8, s[12:15], s6 offen offset:1024 sc1 lds
    s_addk_i32 s6, 8192
    s_add_u32 m0, s7, 94208
    s_nop 0
    buffer_load_dwordx4 v8, s[12:15], s6 offen sc1 lds
    buffer_load_dwordx4 v8, s[12:15], s6 offen offset:1024 sc1 lds
    v_mul_u32_u24 v215, 1280, v3
    v_lshl_add_u32 v214, v4, 4, v215
    v_lshl_add_u32 v215, v4, 3, v215
Hb_block_kernel_8:
    s_cbranch_execz Hb_block_kernel_9
    v_lshrrev_b32 v1, 1, v4
    v_and_b32 v5, 1, v4
    v_lshlrev_b32 v216, 4, v3
    v_lshl_add_u32 v216, v1, 8, v216
    v_lshl_add_u32 v216, v5, 3, v216
    s_mul_i32 s34, s20, 20480
    s_mul_i32 s35, s21, 2560
    s_mul_i32 s29, s20, 20480
    s_add_u32 s35, s35, s29
    s_add_u32 s35, s35, 16777216
    s_mul_i32 s29, s21, 160
    s_add_u32 s34, s34, s29
    buffer_load_dwordx4 v[204:207], v214, s[16:19], s34 offen
    buffer_load_dwordx4 v[208:211], v214, s[16:19], s34 offen offset:64
    buffer_load_dwordx2 v[212:213], v215, s[16:19], s34 offen offset:128
    s_mul_i32 s7, s23, 3072
    s_add_u32 s6, s24, s7
    s_add_u32 s6, s6, 6144
    s_add_u32 m0, s7, 0
    s_nop 0
    buffer_load_dwordx4 v8, s[12:15], s6 offen sc1 lds
    buffer_load_dwordx4 v8, s[12:15], s6 offen offset:1024 sc1 lds
    buffer_load_dwordx4 v8, s[12:15], s6 offen offset:2048 sc1 lds
    s_addk_i32 s6, 12288
    s_add_u32 m0, s7, 20480
    s_nop 0
    buffer_load_dwordx4 v8, s[12:15], s6 offen sc1 lds
    buffer_load_dwordx4 v8, s[12:15], s6 offen offset:1024 sc1 lds
    buffer_load_dwordx4 v8, s[12:15], s6 offen offset:2048 sc1 lds
    s_lshl_b32 s7, s23, 10
    s_add_u32 s6, s24, s7
    s_add_u32 s6, s6, 30720
    s_add_u32 m0, s7, 40960
    s_nop 0
    buffer_load_dwordx4 v8, s[12:15], s6 offen sc1 lds
    s_addk_i32 s6, 4096
    s_add_u32 m0, s7, 45056
    s_nop 0
    buffer_load_dwordx4 v8, s[12:15], s6 offen sc1 lds
    s_addk_i32 s6, 4096
    s_add_u32 m0, s7, 49152
    s_nop 0
    buffer_load_dwordx4 v8, s[12:15], s6 offen sc1 lds
    v_lshlrev_b32 v219, 9, v1
    v_lshl_add_u32 v219, v5, 7, v219
    v_lshl_add_u32 v219, v3, 3, v219
    s_mul_i32 s25, s20, 20480
    s_add_u32 s25, s25, 12582912
    s_lshr_b32 s32, s23, 1
    s_and_b32 s33, s23, 1
    s_mul_i32 s27, s33, 3072
    s_add_u32 s24, s24, s27
    v_and_b32 v5, 0x1ff, v8
    s_waitcnt lgkmcnt(0)
    v_mov_b32 v245, 1
    v_lshlrev_b32 v244, 8, v0
    v_lshrrev_b32 v1, 2, v0
    v_lshl_add_u32 v244, v1, 26, v244
    s_bfe_u32 s26, s2, 0x30003
    s_lshl_b32 s26, s26, 10
    s_add_u32 s26, s26, 37945344
    s_lshr_b32 s28, s20, 2
    s_lshl_b32 s28, s28, 8
    s_add_u32 s28, s28, 37945344
    s_cmp_eq_u32 s22, 1
    s_cselect_b64 exec, 1, 0
    v_mov_b32 v252, 0
    buffer_atomic_or v252, off, s[12:15], s28 sc0 sc1
    s_barrier
    s_waitcnt vmcnt(0)
    v_cmp_gt_u32 vcc, 32, v252
    s_mov_b64 exec, -1
    s_cbranch_vccz L_block_kernel_pq_85
    s_waitcnt vmcnt(1)
    s_cmp_lg_u32 s22, 1
    s_cbranch_scc1 L_block_kernel_po_87
    s_mov_b64 exec, 1
    v_mov_b32 v250, 0
    buffer_atomic_or v250, off, s[12:15], s28 sc0 sc1
    s_movk_i32 s50, 20
L_block_kernel_pd_89:
    s_sub_u32 s50, s50, 1
    s_cbranch_scc0 L_block_kernel_pd_89
    s_movk_i32 s50, 20000
L_block_kernel_poll_86:
    v_mov_b32 v251, 0
    buffer_atomic_or v251, off, s[12:15], s28 sc0 sc1
    s_waitcnt vmcnt(1)
    v_cmp_gt_u32 vcc, 32, v250
    s_cbranch_vccz L_block_kernel_pc_88
    v_mov_b32 v250, 0
    buffer_atomic_or v250, off, s[12:15], s28 sc0 sc1
    s_waitcnt vmcnt(1)
    v_cmp_gt_u32 vcc, 32, v251
    s_cbranch_vccz L_block_kernel_pc_88
    s_sub_u32 s50, s50, 1
    s_cbranch_scc0 L_block_kernel_poll_86
L_block_kernel_pc_88:
    s_mov_b64 exec, -1
L_block_kernel_po_87:
L_block_kernel_pq_85:
    s_barrier
    buffer_load_dwordx4 v[20:23], v8, s[12:15], s25 offen offset:0 sc1
    buffer_load_dwordx4 v[24:27], v8, s[12:15], s25 offen offset:1024 sc1
    buffer_load_dwordx4 v[28:31], v8, s[12:15], s25 offen offset:2048 sc1
    buffer_load_dwordx4 v[32:35], v8, s[12:15], s25 offen offset:3072 sc1
    s_addk_i32 s25, 4096
    buffer_load_dwordx4 v[36:39], v8, s[12:15], s25 offen offset:0 sc1
    buffer_load_dwordx4 v[40:43], v8, s[12:15], s25 offen offset:1024 sc1
    buffer_load_dwordx4 v[44:47], v8, s[12:15], s25 offen offset:2048 sc1
    buffer_load_dwordx4 v[48:51], v8, s[12:15], s25 offen offset:3072 sc1
    s_addk_i32 s25, 4096
    buffer_load_dwordx4 v[52:55], v8, s[12:15], s25 offen offset:0 sc1
    buffer_load_dwordx4 v[56:59], v8, s[12:15], s25 offen offset:1024 sc1
    buffer_load_dwordx4 v[60:63], v8, s[12:15], s25 offen offset:2048 sc1
    buffer_load_dwordx4 v[64:67], v8, s[12:15], s25 offen offset:3072 sc1
    s_addk_i32 s25, 4096
    buffer_load_dwordx4 v[68:71], v8, s[12:15], s25 offen offset:0 sc1
    buffer_load_dwordx4 v[72:75], v8, s[12:15], s25 offen offset:1024 sc1
    buffer_load_dwordx4 v[76:79], v8, s[12:15], s25 offen offset:2048 sc1
    buffer_load_dwordx4 v[80:83], v8, s[12:15], s25 offen offset:3072 sc1
    s_addk_i32 s25, 4096
    buffer_load_dwordx2 v[84:85], v219, s[12:15], s25 offen offset:0 sc1
    buffer_load_dwordx2 v[86:87], v219, s[12:15], s25 offen offset:256 sc1
    buffer_load_dwordx2 v[88:89], v219, s[12:15], s25 offen offset:1024 sc1
    buffer_load_dwordx2 v[90:91], v219, s[12:15], s25 offen offset:1280 sc1
    buffer_load_dwordx2 v[92:93], v219, s[12:15], s25 offen offset:2048 sc1
    buffer_load_dwordx2 v[94:95], v219, s[12:15], s25 offen offset:2304 sc1
    buffer_load_dwordx2 v[96:97], v219, s[12:15], s25 offen offset:3072 sc1
    buffer_load_dwordx2 v[98:99], v219, s[12:15], s25 offen offset:3328 sc1
    s_addk_i32 s25, 4096
    s_barrier
    buffer_load_dwordx4 v[140:143], v5, s[12:15], s24 offen offset:0 sc1
    buffer_load_dwordx4 v[144:147], v5, s[12:15], s24 offen offset:512 sc1
    buffer_load_dwordx4 v[148:151], v5, s[12:15], s24 offen offset:1024 sc1
    buffer_load_dwordx4 v[152:155], v5, s[12:15], s24 offen offset:1536 sc1
    buffer_load_dwordx4 v[156:159], v5, s[12:15], s24 offen offset:2048 sc1
    buffer_load_dwordx4 v[160:163], v5, s[12:15], s24 offen offset:2560 sc1
    v_add_u32 v217, 102400, v8
    v_add_u32 v218, 61440, v8
    v_mov_b32 v245, 1
    v_min_u32 v244, 1, v2
    v_lshlrev_b32 v244, 31, v244
    s_waitcnt vmcnt(30)
    v_lshlrev_b32 v100, 16, v204
    v_and_b32 v101, 0xffff0000, v204
    v_lshlrev_b32 v102, 16, v205
    v_and_b32 v103, 0xffff0000, v205
    v_lshlrev_b32 v104, 16, v206
    v_and_b32 v105, 0xffff0000, v206
    v_lshlrev_b32 v106, 16, v207
    v_and_b32 v107, 0xffff0000, v207
    v_lshlrev_b32 v108, 16, v208
    v_and_b32 v109, 0xffff0000, v208
    v_lshlrev_b32 v110, 16, v209
    v_and_b32 v111, 0xffff0000, v209
    v_lshlrev_b32 v112, 16, v210
    v_and_b32 v113, 0xffff0000, v210
    v_lshlrev_b32 v114, 16, v211
    v_and_b32 v115, 0xffff0000, v211
    v_lshlrev_b32 v116, 16, v212
    v_and_b32 v117, 0xffff0000, v212
    v_lshlrev_b32 v118, 16, v213
    v_and_b32 v119, 0xffff0000, v213
    ds_read_b128 v[164:167], v217 offset:0
    ds_read_b128 v[168:171], v217 offset:1024
    ds_read_b128 v[172:175], v217 offset:2048
    ds_read_b128 v[176:179], v217 offset:3072
    ds_read_b128 v[180:183], v217 offset:4096
    ds_read_b128 v[184:187], v217 offset:5120
    ds_read_b128 v[188:191], v217 offset:6144
Hb_block_kernel_9:
    s_cbranch_execz Hb_block_kernel_10
    ds_read_b128 v[192:195], v217 offset:7168
    ds_read_b128 v[196:199], v217 offset:8192
    ds_read_b128 v[200:203], v217 offset:9216
    s_waitcnt vmcnt(29)
    s_waitcnt lgkmcnt(9)
    v_mfma_f32_16x16x32_bf16 v[100:103], v[164:167], v[20:23], v[100:103]
    ds_read_b128 v[164:167], v217 offset:10240
    s_waitcnt lgkmcnt(9)
    v_mfma_f32_16x16x32_bf16 v[104:107], v[168:171], v[20:23], v[104:107]
    ds_read_b128 v[168:171], v217 offset:11264
    s_waitcnt lgkmcnt(9)
    v_mfma_f32_16x16x32_bf16 v[108:111], v[172:175], v[20:23], v[108:111]
    ds_read_b128 v[172:175], v217 offset:12288
    s_waitcnt lgkmcnt(9)
    v_mfma_f32_16x16x32_bf16 v[112:115], v[176:179], v[20:23], v[112:115]
    ds_read_b128 v[176:179], v217 offset:13312
    s_waitcnt lgkmcnt(9)
    v_mfma_f32_16x16x32_bf16 v[116:119], v[180:183], v[20:23], v[116:119]
    ds_read_b128 v[180:183], v217 offset:14336
    s_waitcnt vmcnt(28)
    s_waitcnt lgkmcnt(9)
    v_mfma_f32_16x16x32_bf16 v[100:103], v[184:187], v[24:27], v[100:103]
    ds_read_b128 v[184:187], v217 offset:15360
    s_waitcnt lgkmcnt(9)
    v_mfma_f32_16x16x32_bf16 v[104:107], v[188:191], v[24:27], v[104:107]
    ds_read_b128 v[188:191], v217 offset:16384
    s_waitcnt lgkmcnt(9)
    v_mfma_f32_16x16x32_bf16 v[108:111], v[192:195], v[24:27], v[108:111]
    ds_read_b128 v[192:195], v217 offset:17408
    s_waitcnt lgkmcnt(9)
    v_mfma_f32_16x16x32_bf16 v[112:115], v[196:199], v[24:27], v[112:115]
    ds_read_b128 v[196:199], v217 offset:18432
    s_waitcnt lgkmcnt(9)
    v_mfma_f32_16x16x32_bf16 v[116:119], v[200:203], v[24:27], v[116:119]
    ds_read_b128 v[200:203], v217 offset:19456
    s_waitcnt vmcnt(27)
    s_waitcnt lgkmcnt(9)
    v_mfma_f32_16x16x32_bf16 v[100:103], v[164:167], v[28:31], v[100:103]
    ds_read_b128 v[164:167], v217 offset:20480
    s_waitcnt lgkmcnt(9)
    v_mfma_f32_16x16x32_bf16 v[104:107], v[168:171], v[28:31], v[104:107]
    ds_read_b128 v[168:171], v217 offset:21504
    s_waitcnt lgkmcnt(9)
    v_mfma_f32_16x16x32_bf16 v[108:111], v[172:175], v[28:31], v[108:111]
    ds_read_b128 v[172:175], v217 offset:22528
    s_waitcnt lgkmcnt(9)
    v_mfma_f32_16x16x32_bf16 v[112:115], v[176:179], v[28:31], v[112:115]
    ds_read_b128 v[176:179], v217 offset:23552
    s_waitcnt lgkmcnt(9)
    v_mfma_f32_16x16x32_bf16 v[116:119], v[180:183], v[28:31], v[116:119]
    ds_read_b128 v[180:183], v217 offset:24576
    s_waitcnt vmcnt(26)
    s_waitcnt lgkmcnt(9)
    v_mfma_f32_16x16x32_bf16 v[100:103], v[184:187], v[32:35], v[100:103]
    ds_read_b128 v[184:187], v217 offset:25600
    s_waitcnt lgkmcnt(9)
    v_mfma_f32_16x16x32_bf16 v[104:107], v[188:191], v[32:35], v[104:107]
    ds_read_b128 v[188:191], v217 offset:26624
    s_waitcnt lgkmcnt(9)
    v_mfma_f32_16x16x32_bf16 v[108:111], v[192:195], v[32:35], v[108:111]
    ds_read_b128 v[192:195], v217 offset:27648
    s_waitcnt lgkmcnt(9)
    v_mfma_f32_16x16x32_bf16 v[112:115], v[196:199], v[32:35], v[112:115]
    ds_read_b128 v[196:199], v217 offset:28672
    s_waitcnt lgkmcnt(9)
    v_mfma_f32_16x16x32_bf16 v[116:119], v[200:203], v[32:35], v[116:119]
    ds_read_b128 v[200:203], v217 offset:29696
    s_waitcnt vmcnt(25)
    s_waitcnt lgkmcnt(9)
    v_mfma_f32_16x16x32_bf16 v[100:103], v[164:167], v[36:39], v[100:103]
    ds_read_b128 v[164:167], v217 offset:30720
    s_waitcnt lgkmcnt(9)
    v_mfma_f32_16x16x32_bf16 v[104:107], v[168:171], v[36:39], v[104:107]
    ds_read_b128 v[168:171], v217 offset:31744
    s_waitcnt lgkmcnt(9)
    v_mfma_f32_16x16x32_bf16 v[108:111], v[172:175], v[36:39], v[108:111]
    ds_read_b128 v[172:175], v217 offset:32768
    s_waitcnt lgkmcnt(9)
    v_mfma_f32_16x16x32_bf16 v[112:115], v[176:179], v[36:39], v[112:115]
    ds_read_b128 v[176:179], v217 offset:33792
    s_waitcnt lgkmcnt(9)
    v_mfma_f32_16x16x32_bf16 v[116:119], v[180:183], v[36:39], v[116:119]
    ds_read_b128 v[180:183], v217 offset:34816
    s_waitcnt vmcnt(24)
    s_waitcnt lgkmcnt(9)
    v_mfma_f32_16x16x32_bf16 v[100:103], v[184:187], v[40:43], v[100:103]
    ds_read_b128 v[184:187], v217 offset:35840
    s_waitcnt lgkmcnt(9)
    v_mfma_f32_16x16x32_bf16 v[104:107], v[188:191], v[40:43], v[104:107]
    ds_read_b128 v[188:191], v217 offset:36864
    s_waitcnt lgkmcnt(9)
    v_mfma_f32_16x16x32_bf16 v[108:111], v[192:195], v[40:43], v[108:111]
    ds_read_b128 v[192:195], v217 offset:37888
    s_waitcnt lgkmcnt(9)
    v_mfma_f32_16x16x32_bf16 v[112:115], v[196:199], v[40:43], v[112:115]
    ds_read_b128 v[196:199], v217 offset:38912
    s_waitcnt lgkmcnt(9)
    v_mfma_f32_16x16x32_bf16 v[116:119], v[200:203], v[40:43], v[116:119]
    ds_read_b128 v[200:203], v217 offset:39936
    s_waitcnt vmcnt(23)
    s_waitcnt lgkmcnt(9)
    v_mfma_f32_16x16x32_bf16 v[100:103], v[164:167], v[44:47], v[100:103]
    ds_read_b128 v[164:167], v217 offset:40960
    s_waitcnt lgkmcnt(9)
    v_mfma_f32_16x16x32_bf16 v[104:107], v[168:171], v[44:47], v[104:107]
    ds_read_b128 v[168:171], v217 offset:41984
    s_waitcnt lgkmcnt(9)
    v_mfma_f32_16x16x32_bf16 v[108:111], v[172:175], v[44:47], v[108:111]
    ds_read_b128 v[172:175], v217 offset:43008
    s_waitcnt lgkmcnt(9)
    v_mfma_f32_16x16x32_bf16 v[112:115], v[176:179], v[44:47], v[112:115]
    ds_read_b128 v[176:179], v217 offset:44032
    s_waitcnt lgkmcnt(9)
    v_mfma_f32_16x16x32_bf16 v[116:119], v[180:183], v[44:47], v[116:119]
    ds_read_b128 v[180:183], v217 offset:45056
    s_waitcnt vmcnt(22)
    s_waitcnt lgkmcnt(9)
    v_mfma_f32_16x16x32_bf16 v[100:103], v[184:187], v[48:51], v[100:103]
    ds_read_b128 v[184:187], v217 offset:46080
    s_waitcnt lgkmcnt(9)
    v_mfma_f32_16x16x32_bf16 v[104:107], v[188:191], v[48:51], v[104:107]
    ds_read_b128 v[188:191], v217 offset:47104
    s_waitcnt lgkmcnt(9)
    v_mfma_f32_16x16x32_bf16 v[108:111], v[192:195], v[48:51], v[108:111]
    ds_read_b128 v[192:195], v217 offset:48128
    s_waitcnt lgkmcnt(9)
    v_mfma_f32_16x16x32_bf16 v[112:115], v[196:199], v[48:51], v[112:115]
    ds_read_b128 v[196:199], v217 offset:49152
    s_waitcnt lgkmcnt(9)
    v_mfma_f32_16x16x32_bf16 v[116:119], v[200:203], v[48:51], v[116:119]
    ds_read_b128 v[200:203], v217 offset:50176
    s_waitcnt vmcnt(21)
    s_waitcnt lgkmcnt(9)
    v_mfma_f32_16x16x32_bf16 v[100:103], v[164:167], v[52:55], v[100:103]
    ds_read_b128 v[164:167], v217 offset:51200
    s_waitcnt lgkmcnt(9)
    v_mfma_f32_16x16x32_bf16 v[104:107], v[168:171], v[52:55], v[104:107]
    ds_read_b128 v[168:171], v217 offset:52224
    s_waitcnt lgkmcnt(9)
    v_mfma_f32_16x16x32_bf16 v[108:111], v[172:175], v[52:55], v[108:111]
    ds_read_b128 v[172:175], v217 offset:53248
    s_waitcnt lgkmcnt(9)
    v_mfma_f32_16x16x32_bf16 v[112:115], v[176:179], v[52:55], v[112:115]
    ds_read_b128 v[176:179], v217 offset:54272
    s_waitcnt lgkmcnt(9)
    v_mfma_f32_16x16x32_bf16 v[116:119], v[180:183], v[52:55], v[116:119]
    ds_read_b128 v[180:183], v217 offset:55296
    s_waitcnt vmcnt(20)
    s_waitcnt lgkmcnt(9)
    v_mfma_f32_16x16x32_bf16 v[100:103], v[184:187], v[56:59], v[100:103]
    ds_read_b128 v[184:187], v217 offset:56320
    s_waitcnt lgkmcnt(9)
    v_mfma_f32_16x16x32_bf16 v[104:107], v[188:191], v[56:59], v[104:107]
    ds_read_b128 v[188:191], v217 offset:57344
    s_waitcnt lgkmcnt(9)
    v_mfma_f32_16x16x32_bf16 v[108:111], v[192:195], v[56:59], v[108:111]
Hb_block_kernel_10:
    s_cbranch_execz Hb_block_kernel_11
    ds_read_b128 v[192:195], v217 offset:58368
    s_waitcnt lgkmcnt(9)
    v_mfma_f32_16x16x32_bf16 v[112:115], v[196:199], v[56:59], v[112:115]
    ds_read_b128 v[196:199], v217 offset:59392
    s_waitcnt lgkmcnt(9)
    v_mfma_f32_16x16x32_bf16 v[116:119], v[200:203], v[56:59], v[116:119]
    ds_read_b128 v[200:203], v217 offset:60416
    s_waitcnt vmcnt(19)
    s_waitcnt lgkmcnt(9)
    v_mfma_f32_16x16x32_bf16 v[100:103], v[164:167], v[60:63], v[100:103]
    ds_read_b128 v[164:167], v8 offset:12288
    s_waitcnt lgkmcnt(9)
    v_mfma_f32_16x16x32_bf16 v[104:107], v[168:171], v[60:63], v[104:107]
    ds_read_b128 v[168:171], v8 offset:13312
    s_waitcnt lgkmcnt(9)
    v_mfma_f32_16x16x32_bf16 v[108:111], v[172:175], v[60:63], v[108:111]
    ds_read_b128 v[172:175], v8 offset:14336
    s_waitcnt lgkmcnt(9)
    v_mfma_f32_16x16x32_bf16 v[112:115], v[176:179], v[60:63], v[112:115]
    ds_read_b128 v[176:179], v8 offset:15360
    s_waitcnt lgkmcnt(9)
    v_mfma_f32_16x16x32_bf16 v[116:119], v[180:183], v[60:63], v[116:119]
    ds_read_b128 v[180:183], v8 offset:16384
    s_waitcnt vmcnt(18)
    s_waitcnt lgkmcnt(9)
    v_mfma_f32_16x16x32_bf16 v[100:103], v[184:187], v[64:67], v[100:103]
    ds_read_b128 v[184:187], v8 offset:17408
    s_waitcnt lgkmcnt(9)
    v_mfma_f32_16x16x32_bf16 v[104:107], v[188:191], v[64:67], v[104:107]
    ds_read_b128 v[188:191], v8 offset:18432
    s_waitcnt lgkmcnt(9)
    v_mfma_f32_16x16x32_bf16 v[108:111], v[192:195], v[64:67], v[108:111]
    ds_read_b128 v[192:195], v8 offset:19456
    s_waitcnt lgkmcnt(9)
    v_mfma_f32_16x16x32_bf16 v[112:115], v[196:199], v[64:67], v[112:115]
    ds_read_b128 v[196:199], v8 offset:32768
    s_waitcnt lgkmcnt(9)
    v_mfma_f32_16x16x32_bf16 v[116:119], v[200:203], v[64:67], v[116:119]
    ds_read_b128 v[200:203], v8 offset:33792
    s_waitcnt vmcnt(17)
    s_waitcnt lgkmcnt(9)
    v_mfma_f32_16x16x32_bf16 v[100:103], v[164:167], v[68:71], v[100:103]
    ds_read_b128 v[164:167], v8 offset:34816
    s_waitcnt lgkmcnt(9)
    v_mfma_f32_16x16x32_bf16 v[104:107], v[168:171], v[68:71], v[104:107]
    ds_read_b128 v[168:171], v8 offset:35840
    s_waitcnt lgkmcnt(9)
    v_mfma_f32_16x16x32_bf16 v[108:111], v[172:175], v[68:71], v[108:111]
    ds_read_b128 v[172:175], v8 offset:36864
    s_waitcnt lgkmcnt(9)
    v_mfma_f32_16x16x32_bf16 v[112:115], v[176:179], v[68:71], v[112:115]
    ds_read_b128 v[176:179], v8 offset:37888
    s_waitcnt lgkmcnt(9)
    v_mfma_f32_16x16x32_bf16 v[116:119], v[180:183], v[68:71], v[116:119]
    ds_read_b128 v[180:183], v8 offset:38912
    s_waitcnt vmcnt(16)
    s_waitcnt lgkmcnt(9)
    v_mfma_f32_16x16x32_bf16 v[100:103], v[184:187], v[72:75], v[100:103]
    ds_read_b128 v[184:187], v8 offset:39936
    s_waitcnt lgkmcnt(9)
    v_mfma_f32_16x16x32_bf16 v[104:107], v[188:191], v[72:75], v[104:107]
    ds_read_b128 v[188:191], v8 offset:53248
    s_waitcnt lgkmcnt(9)
    v_mfma_f32_16x16x32_bf16 v[108:111], v[192:195], v[72:75], v[108:111]
    ds_read_b128 v[192:195], v8 offset:54272
    s_waitcnt lgkmcnt(9)
    v_mfma_f32_16x16x32_bf16 v[112:115], v[196:199], v[72:75], v[112:115]
    ds_read_b128 v[196:199], v8 offset:55296
    s_waitcnt lgkmcnt(9)
    v_mfma_f32_16x16x32_bf16 v[116:119], v[200:203], v[72:75], v[116:119]
    ds_read_b128 v[200:203], v8 offset:56320
    s_waitcnt vmcnt(15)
    s_barrier
    s_waitcnt lgkmcnt(9)
    v_mfma_f32_16x16x32_bf16 v[100:103], v[164:167], v[76:79], v[100:103]
    ds_read_b128 v[164:167], v8 offset:57344
    s_waitcnt lgkmcnt(9)
    v_mfma_f32_16x16x32_bf16 v[104:107], v[168:171], v[76:79], v[104:107]
    ds_read_b128 v[168:171], v8 offset:58368
    s_waitcnt lgkmcnt(9)
    v_mfma_f32_16x16x32_bf16 v[108:111], v[172:175], v[76:79], v[108:111]
    ds_read_b128 v[172:175], v8 offset:59392
    s_waitcnt lgkmcnt(9)
    v_mfma_f32_16x16x32_bf16 v[112:115], v[176:179], v[76:79], v[112:115]
    ds_read_b128 v[176:179], v8 offset:60416
    s_waitcnt lgkmcnt(9)
    v_mfma_f32_16x16x32_bf16 v[116:119], v[180:183], v[76:79], v[116:119]
    ds_read_b128 v[180:183], v218 offset:12288
    s_waitcnt vmcnt(14)
    s_waitcnt lgkmcnt(9)
    v_mfma_f32_16x16x32_bf16 v[100:103], v[184:187], v[80:83], v[100:103]
    ds_read_b128 v[184:187], v218 offset:13312
    s_waitcnt lgkmcnt(9)
    v_mfma_f32_16x16x32_bf16 v[104:107], v[188:191], v[80:83], v[104:107]
    ds_read_b128 v[188:191], v218 offset:14336
    s_waitcnt lgkmcnt(9)
    v_mfma_f32_16x16x32_bf16 v[108:111], v[192:195], v[80:83], v[108:111]
    ds_read_b128 v[192:195], v218 offset:15360
    s_waitcnt lgkmcnt(9)
    v_mfma_f32_16x16x32_bf16 v[112:115], v[196:199], v[80:83], v[112:115]
    ds_read_b128 v[196:199], v218 offset:16384
    s_waitcnt lgkmcnt(9)
    v_mfma_f32_16x16x32_bf16 v[116:119], v[200:203], v[80:83], v[116:119]
    ds_read_b128 v[200:203], v218 offset:17408
    s_waitcnt vmcnt(12)
    s_waitcnt lgkmcnt(9)
    v_mfma_f32_16x16x32_bf16 v[100:103], v[164:167], v[84:87], v[100:103]
    ds_read_b128 v[164:167], v218 offset:18432
    s_waitcnt lgkmcnt(9)
    v_mfma_f32_16x16x32_bf16 v[104:107], v[168:171], v[84:87], v[104:107]
    ds_read_b128 v[168:171], v218 offset:19456
    s_waitcnt lgkmcnt(9)
    v_mfma_f32_16x16x32_bf16 v[108:111], v[172:175], v[84:87], v[108:111]
    ds_read_b128 v[172:175], v218 offset:32768
    s_waitcnt lgkmcnt(9)
    v_mfma_f32_16x16x32_bf16 v[112:115], v[176:179], v[84:87], v[112:115]
    ds_read_b128 v[176:179], v218 offset:33792
    s_waitcnt lgkmcnt(9)
    v_mfma_f32_16x16x32_bf16 v[116:119], v[180:183], v[84:87], v[116:119]
    ds_read_b128 v[180:183], v218 offset:34816
    s_waitcnt vmcnt(10)
    s_waitcnt lgkmcnt(9)
    v_mfma_f32_16x16x32_bf16 v[100:103], v[184:187], v[88:91], v[100:103]
    ds_read_b128 v[184:187], v218 offset:35840
    s_waitcnt lgkmcnt(9)
    v_mfma_f32_16x16x32_bf16 v[104:107], v[188:191], v[88:91], v[104:107]
    ds_read_b128 v[188:191], v218 offset:36864
    s_waitcnt lgkmcnt(9)
    v_mfma_f32_16x16x32_bf16 v[108:111], v[192:195], v[88:91], v[108:111]
    ds_read_b128 v[192:195], v218 offset:37888
    s_waitcnt lgkmcnt(9)
    v_mfma_f32_16x16x32_bf16 v[112:115], v[196:199], v[88:91], v[112:115]
    ds_read_b128 v[196:199], v218 offset:38912
    s_waitcnt lgkmcnt(9)
    v_mfma_f32_16x16x32_bf16 v[116:119], v[200:203], v[88:91], v[116:119]
    ds_read_b128 v[200:203], v218 offset:39936
    s_waitcnt vmcnt(8)
    s_waitcnt lgkmcnt(9)
    v_mfma_f32_16x16x32_bf16 v[100:103], v[164:167], v[92:95], v[100:103]
    s_waitcnt lgkmcnt(8)
    v_mfma_f32_16x16x32_bf16 v[104:107], v[168:171], v[92:95], v[104:107]
    s_waitcnt lgkmcnt(7)
    v_mfma_f32_16x16x32_bf16 v[108:111], v[172:175], v[92:95], v[108:111]
    s_waitcnt lgkmcnt(6)
    v_mfma_f32_16x16x32_bf16 v[112:115], v[176:179], v[92:95], v[112:115]
    s_waitcnt lgkmcnt(5)
    v_mfma_f32_16x16x32_bf16 v[116:119], v[180:183], v[92:95], v[116:119]
    s_waitcnt vmcnt(6)
    s_waitcnt lgkmcnt(4)
    v_mfma_f32_16x16x32_bf16 v[100:103], v[184:187], v[96:99], v[100:103]
    s_waitcnt lgkmcnt(3)
    v_mfma_f32_16x16x32_bf16 v[104:107], v[188:191], v[96:99], v[104:107]
    s_waitcnt lgkmcnt(2)
    v_mfma_f32_16x16x32_bf16 v[108:111], v[192:195], v[96:99], v[108:111]
    s_waitcnt lgkmcnt(1)
    v_mfma_f32_16x16x32_bf16 v[112:115], v[196:199], v[96:99], v[112:115]
    s_waitcnt lgkmcnt(0)
    v_mfma_f32_16x16x32_bf16 v[116:119], v[200:203], v[96:99], v[116:119]
    v_cmp_u_f32 vcc, v100, v100
    s_cbranch_vccnz L_block_kernel_fb_90
Hb_block_kernel_11:
    s_cbranch_execz Hb_block_kernel_12
L_block_kernel_fr_91:
    v_mov_b32 v5, 0x3f803f80
    v_mov_b32 v6, 0
    v_mov_b32 v7, 0
    v_cvt_pk_bf16_f32 v204, v100, v101
    v_cvt_pk_bf16_f32 v205, v102, v103
    v_cvt_pk_bf16_f32 v206, v104, v105
    v_cvt_pk_bf16_f32 v207, v106, v107
    v_cvt_pk_bf16_f32 v208, v108, v109
    v_cvt_pk_bf16_f32 v209, v110, v111
    v_cvt_pk_bf16_f32 v210, v112, v113
    v_cvt_pk_bf16_f32 v211, v114, v115
    v_cvt_pk_bf16_f32 v212, v116, v117
    v_cvt_pk_bf16_f32 v213, v118, v119
    buffer_store_dwordx4 v[204:207], v8, s[12:15], s35 offen sc1
    buffer_store_dwordx4 v[208:211], v8, s[12:15], s35 offen offset:1024 sc1
    buffer_store_dwordx2 v[212:213], v216, s[12:15], s35 offen offset:2048 sc1
    s_lshl_b32 s40, s49, 8
    s_add_u32 s40, s40, s43
    buffer_atomic_add v245, v244, s[12:15], s40 offen sc1
    v_dot2_f32_bf16 v6, v204, v5, v6
    v_dot2_f32_bf16 v7, v204, v204, v7
    v_dot2_f32_bf16 v6, v205, v5, v6
    v_dot2_f32_bf16 v7, v205, v205, v7
    v_dot2_f32_bf16 v6, v206, v5, v6
    v_dot2_f32_bf16 v7, v206, v206, v7
    v_dot2_f32_bf16 v6, v207, v5, v6
    v_dot2_f32_bf16 v7, v207, v207, v7
    v_dot2_f32_bf16 v6, v208, v5, v6
    v_dot2_f32_bf16 v7, v208, v208, v7
    v_dot2_f32_bf16 v6, v209, v5, v6
    v_dot2_f32_bf16 v7, v209, v209, v7
    v_dot2_f32_bf16 v6, v210, v5, v6
    v_dot2_f32_bf16 v7, v210, v210, v7
    v_dot2_f32_bf16 v6, v211, v5, v6
    v_dot2_f32_bf16 v7, v211, v211, v7
    v_dot2_f32_bf16 v6, v212, v5, v6
    v_dot2_f32_bf16 v7, v212, v212, v7
    v_dot2_f32_bf16 v6, v213, v5, v6
    v_dot2_f32_bf16 v7, v213, v213, v7
    s_lshl_b32 s29, s21, 14
    s_lshl_b32 s30, s20, 7
    s_add_u32 s29, s29, s30
    s_add_u32 s29, s29, 19922944
    v_lshrrev_b32 v1, 5, v2
    v_lshlrev_b32 v1, 2, v1
    v_lshl_add_u32 v1, v3, 3, v1
    v_permlane32_swap_b32 v6, v7
    v_add_f32 v6, v6, v7
    v_mov_b32 v7, v6
    s_nop 1
    v_permlane16_swap_b32 v6, v7
    v_add_f32 v6, v6, v7
    buffer_store_dword v6, v1, s[12:15], s29 offen sc1
    s_lshl_b32 s40, s49, 8
    s_add_u32 s40, s40, s43
    v_lshlrev_b32 v1, 14, v4
    v_lshl_add_u32 v1, v3, 3, v1
    s_lshl_b32 s48, s48, 1
    s_add_u32 s48, s48, s32
    s_lshl_b32 s25, s48, 9
    s_add_u32 s25, s25, 19922944
    s_add_u32 s26, s25, 65536
    v_lshlrev_b32 v6, 8, v3
    s_lshl_b32 s27, s27, 1
    v_add_u32 v9, s27, v8
    s_lshl_b32 s30, s32, 12
    s_add_u32 s30, s30, 12288
    v_add_u32 v10, s30, v8
    v_and_b32 v7, 1, v4
    v_mul_u32_u24 v7, 49152, v7
    v_lshl_add_u32 v11, v3, 4, v7
    v_lshrrev_b32 v7, 1, v4
    v_lshl_add_u32 v11, v7, 8, v11
    s_mul_i32 s36, s48, 196608
    s_lshl_b32 s27, s49, 1
    s_add_u32 s27, s27, s33
    s_lshl_b32 s27, s27, 9
    s_add_u32 s36, s36, s27
    s_add_u32 s36, s36, 20971520
    s_add_u32 s37, s36, 98304
    v_add_u32 v246, 4096, v9
    s_mov_b32 s27, 0
    s_mov_b32 s33, -122880
    s_barrier
    s_cmp_lg_u32 s22, 1
    s_cbranch_scc1 L_block_kernel_po_93
    s_movk_i32 s50, 20000
    s_mov_b64 exec, 65535
L_block_kernel_poll_92:
    v_mov_b32 v5, 0
    buffer_atomic_or v5, v6, s[12:15], s43 offen sc0 sc1
L_block_kernel_pc_94:
    s_sub_u32 s50, s50, 1
    s_cselect_b64 s[52:53], 0, -1
    s_waitcnt vmcnt(0)
    v_cmp_gt_u32 vcc, 4, v5
    s_nop 0
    s_and_b64 s[52:53], s[52:53], vcc
    s_cbranch_scc1 L_block_kernel_poll_92
    s_mov_b64 exec, -1
L_block_kernel_po_93:
    s_barrier
    buffer_load_dwordx2 v[196:197], v1, s[12:15], s25 offen offset:0 sc1
    buffer_load_dwordx2 v[198:199], v1, s[12:15], s26 offen offset:0 sc1
    buffer_load_dwordx2 v[200:201], v1, s[12:15], s25 offen offset:128 sc1
    buffer_load_dwordx2 v[202:203], v1, s[12:15], s26 offen offset:128 sc1
    buffer_load_dwordx2 v[204:205], v1, s[12:15], s25 offen offset:256 sc1
    buffer_load_dwordx2 v[206:207], v1, s[12:15], s26 offen offset:256 sc1
    buffer_load_dwordx2 v[208:209], v1, s[12:15], s25 offen offset:384 sc1
    buffer_load_dwordx2 v[210:211], v1, s[12:15], s26 offen offset:384 sc1
    v_lshrrev_b32 v7, 2, v2
    v_lshlrev_b32 v6, 8, v2
    v_lshlrev_b32 v244, 9, v2
    v_lshl_add_u32 v244, v7, 26, v244
    s_and_b32 s29, s23, 1
    s_lshl3_add_u32 s40, s48, s29
    s_lshl_b32 s40, s40, 8
    s_add_u32 s40, s40, 38010880
    s_and_b32 s29, s21, 3
    s_andn2_b32 s43, s20, 3
    s_add_u32 s43, s43, s29
    s_lshl_b32 s43, s43, 9
    s_add_u32 s43, s43, 38076416
    s_mov_b32 s30, 0
L_block_kernel_gs_95:
    v_cmp_lt_u32 vcc, 31, v2
    s_waitcnt vmcnt(0)
    v_pk_add_f32 v[196:197], v[196:197], v[198:199]
    v_pk_add_f32 v[200:201], v[200:201], v[202:203]
    v_pk_add_f32 v[204:205], v[204:205], v[206:207]
    v_pk_add_f32 v[208:209], v[208:209], v[210:211]
    v_mov_b32 v198, v196
    v_mov_b32 v199, v197
    v_mov_b32 v202, v200
    v_mov_b32 v203, v201
    v_mov_b32 v206, v204
    v_mov_b32 v207, v205
    v_mov_b32 v210, v208
    v_mov_b32 v211, v209
    v_permlane32_swap_b32 v196, v198
    v_permlane32_swap_b32 v197, v199
    v_permlane32_swap_b32 v200, v202
    v_permlane32_swap_b32 v201, v203
    v_permlane32_swap_b32 v204, v206
    v_permlane32_swap_b32 v205, v207
    v_permlane32_swap_b32 v208, v210
    v_permlane32_swap_b32 v209, v211
    v_pk_add_f32 v[196:197], v[196:197], v[198:199]
    v_pk_add_f32 v[200:201], v[200:201], v[202:203]
    v_pk_add_f32 v[204:205], v[204:205], v[206:207]
    v_pk_add_f32 v[208:209], v[208:209], v[210:211]
    v_mov_b32 v198, v196
    v_mov_b32 v199, v197
    v_mov_b32 v202, v200
    v_mov_b32 v203, v201
    v_mov_b32 v206, v204
    v_mov_b32 v207, v205
    v_mov_b32 v210, v208
    v_mov_b32 v211, v209
    v_permlane16_swap_b32 v196, v198
    v_permlane16_swap_b32 v197, v199
    v_permlane16_swap_b32 v200, v202
    v_permlane16_swap_b32 v201, v203
    v_permlane16_swap_b32 v204, v206
    v_permlane16_swap_b32 v205, v207
    v_permlane16_swap_b32 v208, v210
    v_permlane16_swap_b32 v209, v211
    v_pk_add_f32 v[196:197], v[196:197], v[198:199]
    v_pk_add_f32 v[200:201], v[200:201], v[202:203]
    v_pk_add_f32 v[204:205], v[204:205], v[206:207]
    v_pk_add_f32 v[208:209], v[208:209], v[210:211]
    v_fma_f32 v196, v197, 0, v196
    v_fma_f32 v200, v201, 0, v200
    v_fma_f32 v204, v205, 0, v204
    v_fma_f32 v208, v209, 0, v208
    v_mul_f32 v196, 0xbacccccd, v196
    v_mul_f32 v200, 0xbacccccd, v200
    v_mul_f32 v204, 0xbacccccd, v204
Hb_block_kernel_12:
    s_cbranch_execz Hb_block_kernel_end
    v_mul_f32 v208, 0xbacccccd, v208
    v_mul_f32 v197, 0x3acccccd, v197
    v_mul_f32 v201, 0x3acccccd, v201
    v_mul_f32 v205, 0x3acccccd, v205
    v_mul_f32 v209, 0x3acccccd, v209
    v_fma_f32 v197, -v196, v196, v197
    v_fma_f32 v201, -v200, v200, v201
    v_fma_f32 v205, -v204, v204, v205
    v_fma_f32 v209, -v208, v208, v209
    v_cvt_pk_bf16_f32 v180, v196, v196
    v_cvt_pk_bf16_f32 v184, v200, v200
    v_cvt_pk_bf16_f32 v188, v204, v204
    v_cvt_pk_bf16_f32 v192, v208, v208
    v_max_f32 v197, 0, v197
    v_max_f32 v201, 0, v201
    v_max_f32 v205, 0, v205
    v_max_f32 v209, 0, v209
    v_and_b32 v198, 0xffff0000, v180
    v_and_b32 v202, 0xffff0000, v184
    v_and_b32 v206, 0xffff0000, v188
    v_and_b32 v210, 0xffff0000, v192
    v_add_f32 v16, 0x3727c5ac, v197
    v_add_f32 v17, 0x3727c5ac, v201
    v_add_f32 v18, 0x3727c5ac, v205
    v_add_f32 v19, 0x3727c5ac, v209
    v_sub_f32 v198, v196, v198
    v_sub_f32 v202, v200, v202
    v_sub_f32 v206, v204, v206
    v_sub_f32 v210, v208, v210
    v_rsq_f32 v12, v16
    v_rsq_f32 v13, v17
    v_rsq_f32 v14, v18
    v_rsq_f32 v15, v19
    v_cvt_pk_bf16_f32 v198, v198, v198
    v_cvt_pk_bf16_f32 v202, v202, v202
    v_cvt_pk_bf16_f32 v206, v206, v206
    v_cvt_pk_bf16_f32 v210, v210, v210
    v_cndmask_b32 v180, v180, v198, vcc
    v_cndmask_b32 v184, v184, v202, vcc
    v_cndmask_b32 v188, v188, v206, vcc
    v_cndmask_b32 v192, v192, v210, vcc
    v_mul_f32 v12, 0xbfb8aa3b, v12
    v_mul_f32 v13, 0xbfb8aa3b, v13
    v_mul_f32 v14, 0xbfb8aa3b, v14
    v_mul_f32 v15, 0xbfb8aa3b, v15
    v_mov_b32 v181, v180
    v_mov_b32 v185, v184
    v_mov_b32 v189, v188
    v_mov_b32 v193, v192
    v_mov_b32 v182, v180
    v_mov_b32 v186, v184
    v_mov_b32 v190, v188
    v_mov_b32 v194, v192
    v_mov_b32 v183, v180
    v_mov_b32 v187, v184
    v_mov_b32 v191, v188
    v_mov_b32 v195, v192
    v_mfma_f32_16x16x32_bf16 v[20:23], v[140:143], v[180:183], 0
    v_mfma_f32_16x16x32_bf16 v[24:27], v[140:143], v[184:187], 0
    v_mfma_f32_16x16x32_bf16 v[28:31], v[140:143], v[188:191], 0
    v_mfma_f32_16x16x32_bf16 v[32:35], v[140:143], v[192:195], 0
    v_mfma_f32_16x16x32_bf16 v[36:39], v[144:147], v[180:183], 0
    v_mfma_f32_16x16x32_bf16 v[40:43], v[144:147], v[184:187], 0
    v_mfma_f32_16x16x32_bf16 v[44:47], v[144:147], v[188:191], 0
    v_mfma_f32_16x16x32_bf16 v[48:51], v[144:147], v[192:195], 0
    v_mfma_f32_16x16x32_bf16 v[52:55], v[148:151], v[180:183], 0
    v_mfma_f32_16x16x32_bf16 v[56:59], v[148:151], v[184:187], 0
    v_mfma_f32_16x16x32_bf16 v[60:63], v[148:151], v[188:191], 0
    v_mfma_f32_16x16x32_bf16 v[64:67], v[148:151], v[192:195], 0
    v_mfma_f32_16x16x32_bf16 v[68:71], v[152:155], v[180:183], 0
    v_mfma_f32_16x16x32_bf16 v[72:75], v[152:155], v[184:187], 0
    v_mfma_f32_16x16x32_bf16 v[76:79], v[152:155], v[188:191], 0
    v_mfma_f32_16x16x32_bf16 v[80:83], v[152:155], v[192:195], 0
    v_mfma_f32_16x16x32_bf16 v[84:87], v[156:159], v[180:183], 0
    v_mfma_f32_16x16x32_bf16 v[88:91], v[156:159], v[184:187], 0
    v_mfma_f32_16x16x32_bf16 v[92:95], v[156:159], v[188:191], 0
    v_mfma_f32_16x16x32_bf16 v[96:99], v[156:159], v[192:195], 0
    v_mfma_f32_16x16x32_bf16 v[100:103], v[160:163], v[180:183], 0
    v_mfma_f32_16x16x32_bf16 v[104:107], v[160:163], v[184:187], 0
    v_mfma_f32_16x16x32_bf16 v[108:111], v[160:163], v[188:191], 0
    v_mfma_f32_16x16x32_bf16 v[112:115], v[160:163], v[192:195], 0
    s_cmp_lg_u32 s30, 0
    s_cbranch_scc1 L_block_kernel_gb_96
    s_barrier
    ds_read_b128 v[116:119], v9 offset:0
    ds_read_b128 v[164:167], v10 offset:0
    ds_read_b128 v[168:171], v10 offset:1024
    ds_read_b128 v[172:175], v10 offset:2048
    ds_read_b128 v[176:179], v10 offset:3072
    ds_read_b128 v[120:123], v9 offset:1024
    ds_read_b128 v[124:127], v9 offset:2048
    ds_read_b128 v[128:131], v9 offset:3072
    ds_read_b128 v[132:135], v9 offset:4096
    ds_read_b128 v[136:139], v9 offset:5120
L_block_kernel_loop_99:
    s_waitcnt lgkmcnt(0)
    v_mfma_f32_16x16x32_bf16 v[20:23], v[116:119], v[164:167], v[20:23]
    s_barrier
    ds_read_b128 v[140:143], v9 offset:20480
    v_mfma_f32_16x16x32_bf16 v[24:27], v[116:119], v[168:171], v[24:27]
    ds_read_b128 v[180:183], v10 offset:20480
    v_mfma_f32_16x16x32_bf16 v[28:31], v[116:119], v[172:175], v[28:31]
    ds_read_b128 v[184:187], v10 offset:21504
    v_mfma_f32_16x16x32_bf16 v[32:35], v[116:119], v[176:179], v[32:35]
    ds_read_b128 v[188:191], v10 offset:22528
    v_mfma_f32_16x16x32_bf16 v[48:51], v[120:123], v[176:179], v[48:51]
    ds_read_b128 v[192:195], v10 offset:23552
    v_mfma_f32_16x16x32_bf16 v[44:47], v[120:123], v[172:175], v[44:47]
    ds_read_b128 v[144:147], v9 offset:21504
    v_mfma_f32_16x16x32_bf16 v[40:43], v[120:123], v[168:171], v[40:43]
    ds_read_b128 v[148:151], v9 offset:22528
    v_mfma_f32_16x16x32_bf16 v[36:39], v[120:123], v[164:167], v[36:39]
    ds_read_b128 v[152:155], v9 offset:23552
    v_mfma_f32_16x16x32_bf16 v[52:55], v[124:127], v[164:167], v[52:55]
    ds_read_b128 v[156:159], v9 offset:24576
    v_mfma_f32_16x16x32_bf16 v[56:59], v[124:127], v[168:171], v[56:59]
    ds_read_b128 v[160:163], v9 offset:25600
    v_mfma_f32_16x16x32_bf16 v[60:63], v[124:127], v[172:175], v[60:63]
    v_mfma_f32_16x16x32_bf16 v[64:67], v[124:127], v[176:179], v[64:67]
    v_mfma_f32_16x16x32_bf16 v[80:83], v[128:131], v[176:179], v[80:83]
    v_mfma_f32_16x16x32_bf16 v[76:79], v[128:131], v[172:175], v[76:79]
    v_mfma_f32_16x16x32_bf16 v[72:75], v[128:131], v[168:171], v[72:75]
    v_mfma_f32_16x16x32_bf16 v[68:71], v[128:131], v[164:167], v[68:71]
    v_mfma_f32_16x16x32_bf16 v[84:87], v[132:135], v[164:167], v[84:87]
    v_mfma_f32_16x16x32_bf16 v[88:91], v[132:135], v[168:171], v[88:91]
    v_mfma_f32_16x16x32_bf16 v[92:95], v[132:135], v[172:175], v[92:95]
    v_mfma_f32_16x16x32_bf16 v[96:99], v[132:135], v[176:179], v[96:99]
    v_mfma_f32_16x16x32_bf16 v[112:115], v[136:139], v[176:179], v[112:115]
    s_add_u32 s27, s27, 1
    s_and_b32 s25, s27, 3
    s_cselect_b32 s25, 40960, s33
    v_mfma_f32_16x16x32_bf16 v[108:111], v[136:139], v[172:175], v[108:111]
    v_add_u32 v9, s25, v9
    v_mfma_f32_16x16x32_bf16 v[104:107], v[136:139], v[168:171], v[104:107]
    v_add_u32 v10, s25, v10
    s_cmp_lt_u32 s27, 8
    v_mfma_f32_16x16x32_bf16 v[100:103], v[136:139], v[164:167], v[100:103]
    s_waitcnt lgkmcnt(0)
    v_mfma_f32_16x16x32_bf16 v[20:23], v[140:143], v[180:183], v[20:23]
    s_barrier
    ds_read_b128 v[116:119], v9 offset:0
    v_mfma_f32_16x16x32_bf16 v[24:27], v[140:143], v[184:187], v[24:27]
    ds_read_b128 v[164:167], v10 offset:0
    v_mfma_f32_16x16x32_bf16 v[28:31], v[140:143], v[188:191], v[28:31]
    ds_read_b128 v[168:171], v10 offset:1024
    v_mfma_f32_16x16x32_bf16 v[32:35], v[140:143], v[192:195], v[32:35]
    ds_read_b128 v[172:175], v10 offset:2048
    v_mfma_f32_16x16x32_bf16 v[48:51], v[144:147], v[192:195], v[48:51]
Hb_block_kernel_seg3:
Hb_block_kernel_13:
    s_cbranch_execz Hb_block_kernel_14
    ds_read_b128 v[176:179], v10 offset:3072
    v_mfma_f32_16x16x32_bf16 v[44:47], v[144:147], v[188:191], v[44:47]
    ds_read_b128 v[120:123], v9 offset:1024
    v_mfma_f32_16x16x32_bf16 v[40:43], v[144:147], v[184:187], v[40:43]
    ds_read_b128 v[124:127], v9 offset:2048
    v_mfma_f32_16x16x32_bf16 v[36:39], v[144:147], v[180:183], v[36:39]
    ds_read_b128 v[128:131], v9 offset:3072
    v_mfma_f32_16x16x32_bf16 v[52:55], v[148:151], v[180:183], v[52:55]
    ds_read_b128 v[132:135], v9 offset:4096
    v_mfma_f32_16x16x32_bf16 v[56:59], v[148:151], v[184:187], v[56:59]
    ds_read_b128 v[136:139], v9 offset:5120
    v_mfma_f32_16x16x32_bf16 v[60:63], v[148:151], v[188:191], v[60:63]
    v_mfma_f32_16x16x32_bf16 v[64:67], v[148:151], v[192:195], v[64:67]
    v_mfma_f32_16x16x32_bf16 v[80:83], v[152:155], v[192:195], v[80:83]
    v_mfma_f32_16x16x32_bf16 v[76:79], v[152:155], v[188:191], v[76:79]
    v_mfma_f32_16x16x32_bf16 v[72:75], v[152:155], v[184:187], v[72:75]
    v_mfma_f32_16x16x32_bf16 v[68:71], v[152:155], v[180:183], v[68:71]
    v_mfma_f32_16x16x32_bf16 v[84:87], v[156:159], v[180:183], v[84:87]
    v_mfma_f32_16x16x32_bf16 v[88:91], v[156:159], v[184:187], v[88:91]
    v_mfma_f32_16x16x32_bf16 v[92:95], v[156:159], v[188:191], v[92:95]
    v_mfma_f32_16x16x32_bf16 v[96:99], v[156:159], v[192:195], v[96:99]
    v_mfma_f32_16x16x32_bf16 v[112:115], v[160:163], v[192:195], v[112:115]
    v_mfma_f32_16x16x32_bf16 v[108:111], v[160:163], v[188:191], v[108:111]
    v_mfma_f32_16x16x32_bf16 v[104:107], v[160:163], v[184:187], v[104:107]
    v_mfma_f32_16x16x32_bf16 v[100:103], v[160:163], v[180:183], v[100:103]
    s_cbranch_scc1 L_block_kernel_loop_99
L_block_kernel_tail_100:
    s_waitcnt lgkmcnt(0)
    v_mfma_f32_16x16x32_bf16 v[20:23], v[116:119], v[164:167], v[20:23]
    s_barrier
    ds_read_b128 v[180:183], v10 offset:20480
    v_mfma_f32_16x16x32_bf16 v[24:27], v[116:119], v[168:171], v[24:27]
    ds_read_b128 v[184:187], v10 offset:21504
    v_mfma_f32_16x16x32_bf16 v[28:31], v[116:119], v[172:175], v[28:31]
    ds_read_b128 v[188:191], v10 offset:22528
    v_mfma_f32_16x16x32_bf16 v[32:35], v[116:119], v[176:179], v[32:35]
    ds_read_b128 v[192:195], v10 offset:23552
    ds_read_b128 v[140:143], v9 offset:20480
    v_mfma_f32_16x16x32_bf16 v[36:39], v[120:123], v[164:167], v[36:39]
    ds_read_b128 v[144:147], v9 offset:21504
    v_mfma_f32_16x16x32_bf16 v[40:43], v[120:123], v[168:171], v[40:43]
    s_barrier
    v_mfma_f32_16x16x32_bf16 v[44:47], v[120:123], v[172:175], v[44:47]
    ds_read_b128 v[196:199], v10 offset:40960
    ds_read_b128 v[200:203], v10 offset:41984
    v_mfma_f32_16x16x32_bf16 v[48:51], v[120:123], v[176:179], v[48:51]
    ds_read_b128 v[204:207], v10 offset:43008
    v_mfma_f32_16x16x32_bf16 v[52:55], v[124:127], v[164:167], v[52:55]
    ds_read_b128 v[208:211], v10 offset:44032
    v_mfma_f32_16x16x32_bf16 v[56:59], v[124:127], v[168:171], v[56:59]
    ds_read_b128 v[228:231], v9 offset:40960
    ds_read_b128 v[232:235], v9 offset:41984
    v_mfma_f32_16x16x32_bf16 v[60:63], v[124:127], v[172:175], v[60:63]
    s_barrier
    v_mfma_f32_16x16x32_bf16 v[64:67], v[124:127], v[176:179], v[64:67]
    ds_read_b128 v[212:215], v10 offset:61440
    v_mfma_f32_16x16x32_bf16 v[68:71], v[128:131], v[164:167], v[68:71]
    ds_read_b128 v[216:219], v10 offset:62464
    ds_read_b128 v[220:223], v10 offset:63488
    v_mfma_f32_16x16x32_bf16 v[72:75], v[128:131], v[168:171], v[72:75]
    ds_read_b128 v[224:227], v10 offset:64512
    v_mfma_f32_16x16x32_bf16 v[76:79], v[128:131], v[172:175], v[76:79]
    ds_read_b128 v[236:239], v9 offset:61440
    v_mfma_f32_16x16x32_bf16 v[80:83], v[128:131], v[176:179], v[80:83]
    ds_read_b128 v[240:243], v9 offset:62464
    s_waitcnt lgkmcnt(12)
    v_mfma_f32_16x16x32_bf16 v[20:23], v[140:143], v[180:183], v[20:23]
    ds_read_b128 v[148:151], v9 offset:22528
    v_mfma_f32_16x16x32_bf16 v[24:27], v[140:143], v[184:187], v[24:27]
    v_mfma_f32_16x16x32_bf16 v[28:31], v[140:143], v[188:191], v[28:31]
    ds_read_b128 v[152:155], v9 offset:23552
    v_mfma_f32_16x16x32_bf16 v[32:35], v[140:143], v[192:195], v[32:35]
    v_mfma_f32_16x16x32_bf16 v[36:39], v[144:147], v[180:183], v[36:39]
    ds_read_b128 v[116:119], v9 offset:43008
    v_mfma_f32_16x16x32_bf16 v[40:43], v[144:147], v[184:187], v[40:43]
    v_mfma_f32_16x16x32_bf16 v[44:47], v[144:147], v[188:191], v[44:47]
    ds_read_b128 v[120:123], v9 offset:44032
    v_mfma_f32_16x16x32_bf16 v[48:51], v[144:147], v[192:195], v[48:51]
    s_waitcnt lgkmcnt(10)
    v_mfma_f32_16x16x32_bf16 v[20:23], v[228:231], v[196:199], v[20:23]
    ds_read_b128 v[140:143], v9 offset:63488
    v_mfma_f32_16x16x32_bf16 v[24:27], v[228:231], v[200:203], v[24:27]
    v_mfma_f32_16x16x32_bf16 v[28:31], v[228:231], v[204:207], v[28:31]
    ds_read_b128 v[144:147], v9 offset:64512
    v_mfma_f32_16x16x32_bf16 v[32:35], v[228:231], v[208:211], v[32:35]
    v_mfma_f32_16x16x32_bf16 v[36:39], v[232:235], v[196:199], v[36:39]
    ds_read_b128 v[156:159], v9 offset:24576
    v_mfma_f32_16x16x32_bf16 v[40:43], v[232:235], v[200:203], v[40:43]
    v_mfma_f32_16x16x32_bf16 v[44:47], v[232:235], v[204:207], v[44:47]
    ds_read_b128 v[160:163], v9 offset:25600
    v_mfma_f32_16x16x32_bf16 v[48:51], v[232:235], v[208:211], v[48:51]
    s_waitcnt lgkmcnt(8)
    v_mfma_f32_16x16x32_bf16 v[20:23], v[236:239], v[212:215], v[20:23]
    ds_read_b128 v[228:231], v9 offset:45056
    v_mfma_f32_16x16x32_bf16 v[24:27], v[236:239], v[216:219], v[24:27]
    v_mfma_f32_16x16x32_bf16 v[28:31], v[236:239], v[220:223], v[28:31]
    v_mfma_f32_16x16x32_bf16 v[32:35], v[236:239], v[224:227], v[32:35]
    v_mfma_f32_16x16x32_bf16 v[36:39], v[240:243], v[212:215], v[36:39]
    ds_read_b128 v[232:235], v9 offset:46080
    v_mfma_f32_16x16x32_bf16 v[40:43], v[240:243], v[216:219], v[40:43]
    v_mfma_f32_16x16x32_bf16 v[44:47], v[240:243], v[220:223], v[44:47]
    v_mfma_f32_16x16x32_bf16 v[48:51], v[240:243], v[224:227], v[48:51]
    s_waitcnt lgkmcnt(2)
    v_mfma_f32_16x16x32_bf16 v[52:55], v[148:151], v[180:183], v[52:55]
    ds_read_b128 v[236:239], v246 offset:61440
    ds_read_b128 v[240:243], v246 offset:62464
    v_mfma_f32_16x16x32_bf16 v[56:59], v[148:151], v[184:187], v[56:59]
    v_cmp_u_f32 vcc, v20, v24
    v_cmp_u_f32 s[28:29], v28, v32
    s_nop 0
    s_or_b64 s[28:29], s[28:29], vcc
    s_cbranch_scc1 L_block_kernel_gf_97
L_block_kernel_gr_98:
    v_mul_f32 v36, v36, v20
    v_mul_f32 v20, v20, v12
    v_mul_f32 v37, v37, v21
    v_mul_f32 v21, v21, v12
    v_mfma_f32_16x16x32_bf16 v[60:63], v[148:151], v[188:191], v[60:63]
    v_mul_f32 v38, v38, v22
    v_mul_f32 v22, v22, v12
    v_mul_f32 v39, v39, v23
    v_mul_f32 v23, v23, v12
    v_mul_f32 v40, v40, v24
    v_mul_f32 v24, v24, v13
    v_mfma_f32_16x16x32_bf16 v[64:67], v[148:151], v[192:195], v[64:67]
    v_mul_f32 v41, v41, v25
    v_mul_f32 v25, v25, v13
    v_mul_f32 v42, v42, v26
    v_mul_f32 v26, v26, v13
    v_mul_f32 v43, v43, v27
    v_mfma_f32_16x16x32_bf16 v[68:71], v[152:155], v[180:183], v[68:71]
    v_mul_f32 v27, v27, v13
    v_exp_f32 v20, v20
    v_exp_f32 v21, v21
    v_exp_f32 v22, v22
    v_mfma_f32_16x16x32_bf16 v[72:75], v[152:155], v[184:187], v[72:75]
    v_exp_f32 v23, v23
    v_exp_f32 v24, v24
    v_mfma_f32_16x16x32_bf16 v[76:79], v[152:155], v[188:191], v[76:79]
    v_exp_f32 v25, v25
    v_exp_f32 v26, v26
    v_exp_f32 v27, v27
    v_mfma_f32_16x16x32_bf16 v[80:83], v[152:155], v[192:195], v[80:83]
    v_fma_f32 v20, v20, v16, v16
    v_fma_f32 v21, v21, v16, v16
    v_fma_f32 v22, v22, v16, v16
    v_fma_f32 v23, v23, v16, v16
    v_fma_f32 v24, v24, v17, v17
Hb_block_kernel_14:
    s_cbranch_execz Hb_block_kernel_15
    v_mfma_f32_16x16x32_bf16 v[52:55], v[116:119], v[196:199], v[52:55]
    v_fma_f32 v25, v25, v17, v17
    v_fma_f32 v26, v26, v17, v17
    v_fma_f32 v27, v27, v17, v17
    v_rcp_f32 v20, v20
    v_rcp_f32 v21, v21
    v_mfma_f32_16x16x32_bf16 v[56:59], v[116:119], v[200:203], v[56:59]
    v_rcp_f32 v22, v22
    v_rcp_f32 v23, v23
    v_mfma_f32_16x16x32_bf16 v[60:63], v[116:119], v[204:207], v[60:63]
    v_rcp_f32 v24, v24
    v_rcp_f32 v25, v25
    v_rcp_f32 v26, v26
    v_mfma_f32_16x16x32_bf16 v[64:67], v[116:119], v[208:211], v[64:67]
    v_rcp_f32 v27, v27
    v_mul_f32 v36, v36, v20
    v_mul_f32 v37, v37, v21
    v_mul_f32 v38, v38, v22
    v_mfma_f32_16x16x32_bf16 v[68:71], v[120:123], v[196:199], v[68:71]
    v_mul_f32 v39, v39, v23
    v_mul_f32 v40, v40, v24
    v_mul_f32 v41, v41, v25
    v_mul_f32 v42, v42, v26
    v_mul_f32 v43, v43, v27
    v_cvt_pk_bf16_f32 v20, v36, v37
    v_mfma_f32_16x16x32_bf16 v[72:75], v[120:123], v[200:203], v[72:75]
    v_cvt_pk_bf16_f32 v22, v40, v41
    v_cvt_pk_bf16_f32 v21, v38, v39
    v_cvt_pk_bf16_f32 v23, v42, v43
    v_permlane16_swap_b32 v20, v22
    s_nop 0
    v_permlane16_swap_b32 v21, v23
    v_mfma_f32_16x16x32_bf16 v[76:79], v[120:123], v[204:207], v[76:79]
    buffer_store_dwordx4 v[20:23], v11, s[12:15], s36 offen sc1
    s_addk_i32 s36, 16384
    v_mul_f32 v44, v44, v28
    v_mul_f32 v28, v28, v14
    v_mul_f32 v45, v45, v29
    v_mul_f32 v29, v29, v14
    v_mul_f32 v46, v46, v30
    v_mfma_f32_16x16x32_bf16 v[80:83], v[120:123], v[208:211], v[80:83]
    v_mul_f32 v30, v30, v14
    v_mul_f32 v47, v47, v31
    v_mul_f32 v31, v31, v14
    v_mul_f32 v48, v48, v32
    v_mul_f32 v32, v32, v15
    v_mul_f32 v49, v49, v33
    v_mfma_f32_16x16x32_bf16 v[52:55], v[140:143], v[212:215], v[52:55]
    v_mul_f32 v33, v33, v15
    v_mul_f32 v50, v50, v34
    v_mul_f32 v34, v34, v15
    v_mul_f32 v51, v51, v35
    v_mul_f32 v35, v35, v15
    v_mfma_f32_16x16x32_bf16 v[56:59], v[140:143], v[216:219], v[56:59]
    v_exp_f32 v28, v28
    v_exp_f32 v29, v29
    v_exp_f32 v30, v30
    v_mfma_f32_16x16x32_bf16 v[60:63], v[140:143], v[220:223], v[60:63]
    v_exp_f32 v31, v31
    v_exp_f32 v32, v32
    v_exp_f32 v33, v33
    v_mfma_f32_16x16x32_bf16 v[64:67], v[140:143], v[224:227], v[64:67]
    v_exp_f32 v34, v34
    v_exp_f32 v35, v35
    s_waitcnt lgkmcnt(0)
    s_barrier
    v_fma_f32 v28, v28, v18, v18
    v_mfma_f32_16x16x32_bf16 v[68:71], v[144:147], v[212:215], v[68:71]
    v_fma_f32 v29, v29, v18, v18
    v_fma_f32 v30, v30, v18, v18
    v_fma_f32 v31, v31, v18, v18
    v_fma_f32 v32, v32, v19, v19
    v_fma_f32 v33, v33, v19, v19
    v_mfma_f32_16x16x32_bf16 v[72:75], v[144:147], v[216:219], v[72:75]
    v_fma_f32 v34, v34, v19, v19
    v_fma_f32 v35, v35, v19, v19
    v_rcp_f32 v28, v28
    v_rcp_f32 v29, v29
    v_mfma_f32_16x16x32_bf16 v[76:79], v[144:147], v[220:223], v[76:79]
    v_rcp_f32 v30, v30
    v_rcp_f32 v31, v31
    v_rcp_f32 v32, v32
    v_mfma_f32_16x16x32_bf16 v[80:83], v[144:147], v[224:227], v[80:83]
    v_rcp_f32 v33, v33
    v_rcp_f32 v34, v34
    v_rcp_f32 v35, v35
    v_mfma_f32_16x16x32_bf16 v[84:87], v[132:135], v[164:167], v[84:87]
    v_mul_f32 v44, v44, v28
    v_mul_f32 v45, v45, v29
    v_mul_f32 v46, v46, v30
    v_mul_f32 v47, v47, v31
    v_mfma_f32_16x16x32_bf16 v[88:91], v[132:135], v[168:171], v[88:91]
    v_mul_f32 v48, v48, v32
    v_mul_f32 v49, v49, v33
    v_mul_f32 v50, v50, v34
    v_mul_f32 v51, v51, v35
    v_cvt_pk_bf16_f32 v28, v44, v45
    v_cvt_pk_bf16_f32 v30, v48, v49
    v_mfma_f32_16x16x32_bf16 v[92:95], v[132:135], v[172:175], v[92:95]
    v_cvt_pk_bf16_f32 v29, v46, v47
    v_cvt_pk_bf16_f32 v31, v50, v51
    v_permlane16_swap_b32 v28, v30
    s_nop 0
    v_permlane16_swap_b32 v29, v31
    buffer_store_dwordx4 v[28:31], v11, s[12:15], s37 offen sc1
    v_mfma_f32_16x16x32_bf16 v[96:99], v[132:135], v[176:179], v[96:99]
    s_addk_i32 s37, 16384
    v_mul_f32 v68, v68, v52
    v_mul_f32 v52, v52, v12
    v_mul_f32 v69, v69, v53
    v_mul_f32 v53, v53, v12
    v_mul_f32 v70, v70, v54
    v_mul_f32 v54, v54, v12
    v_mfma_f32_16x16x32_bf16 v[100:103], v[136:139], v[164:167], v[100:103]
    v_mul_f32 v71, v71, v55
    v_mul_f32 v55, v55, v12
    v_mul_f32 v72, v72, v56
    v_mul_f32 v56, v56, v13
    v_mul_f32 v73, v73, v57
    v_mfma_f32_16x16x32_bf16 v[104:107], v[136:139], v[168:171], v[104:107]
    v_mul_f32 v57, v57, v13
    v_mul_f32 v74, v74, v58
    v_mul_f32 v58, v58, v13
    v_mul_f32 v75, v75, v59
    v_mul_f32 v59, v59, v13
    v_mfma_f32_16x16x32_bf16 v[108:111], v[136:139], v[172:175], v[108:111]
    v_exp_f32 v52, v52
    v_exp_f32 v53, v53
    v_exp_f32 v54, v54
    v_mfma_f32_16x16x32_bf16 v[112:115], v[136:139], v[176:179], v[112:115]
    v_exp_f32 v55, v55
    v_exp_f32 v56, v56
    v_mfma_f32_16x16x32_bf16 v[84:87], v[156:159], v[180:183], v[84:87]
    v_exp_f32 v57, v57
    v_exp_f32 v58, v58
    v_exp_f32 v59, v59
    v_mfma_f32_16x16x32_bf16 v[88:91], v[156:159], v[184:187], v[88:91]
    v_fma_f32 v52, v52, v16, v16
    v_fma_f32 v53, v53, v16, v16
    v_fma_f32 v54, v54, v16, v16
    v_fma_f32 v55, v55, v16, v16
    v_mfma_f32_16x16x32_bf16 v[92:95], v[156:159], v[188:191], v[92:95]
    v_fma_f32 v56, v56, v17, v17
    v_fma_f32 v57, v57, v17, v17
    v_fma_f32 v58, v58, v17, v17
    v_fma_f32 v59, v59, v17, v17
    v_rcp_f32 v52, v52
    v_mfma_f32_16x16x32_bf16 v[96:99], v[156:159], v[192:195], v[96:99]
    v_rcp_f32 v53, v53
    v_rcp_f32 v54, v54
    v_mfma_f32_16x16x32_bf16 v[100:103], v[160:163], v[180:183], v[100:103]
    v_rcp_f32 v55, v55
    v_rcp_f32 v56, v56
    v_rcp_f32 v57, v57
    v_mfma_f32_16x16x32_bf16 v[104:107], v[160:163], v[184:187], v[104:107]
    v_rcp_f32 v58, v58
    v_rcp_f32 v59, v59
    v_mul_f32 v68, v68, v52
    v_mfma_f32_16x16x32_bf16 v[108:111], v[160:163], v[188:191], v[108:111]
    v_mul_f32 v69, v69, v53
    v_mul_f32 v70, v70, v54
    v_mul_f32 v71, v71, v55
    v_mul_f32 v72, v72, v56
    v_mul_f32 v73, v73, v57
    v_mfma_f32_16x16x32_bf16 v[112:115], v[160:163], v[192:195], v[112:115]
    v_mul_f32 v74, v74, v58
    v_mul_f32 v75, v75, v59
    v_cvt_pk_bf16_f32 v52, v68, v69
    v_cvt_pk_bf16_f32 v54, v72, v73
    v_cvt_pk_bf16_f32 v53, v70, v71
    v_mfma_f32_16x16x32_bf16 v[84:87], v[228:231], v[196:199], v[84:87]
    v_cvt_pk_bf16_f32 v55, v74, v75
    v_permlane16_swap_b32 v52, v54
    s_nop 0
    v_permlane16_swap_b32 v53, v55
    buffer_store_dwordx4 v[52:55], v11, s[12:15], s36 offen sc1
    s_addk_i32 s36, 16384
    v_mul_f32 v76, v76, v60
    v_mfma_f32_16x16x32_bf16 v[88:91], v[228:231], v[200:203], v[88:91]
    v_mul_f32 v60, v60, v14
    v_mul_f32 v77, v77, v61
    v_mul_f32 v61, v61, v14
    v_mul_f32 v78, v78, v62
    v_mul_f32 v62, v62, v14
    v_mfma_f32_16x16x32_bf16 v[92:95], v[228:231], v[204:207], v[92:95]
    v_mul_f32 v79, v79, v63
Hb_block_kernel_15:
    s_cbranch_execz Hb_block_kernel_16
    v_mul_f32 v63, v63, v14
    v_mul_f32 v80, v80, v64
    v_mul_f32 v64, v64, v15
    v_mul_f32 v81, v81, v65
    v_mfma_f32_16x16x32_bf16 v[96:99], v[228:231], v[208:211], v[96:99]
    v_mul_f32 v65, v65, v15
    v_mul_f32 v82, v82, v66
    v_mul_f32 v66, v66, v15
    v_mul_f32 v83, v83, v67
    v_mul_f32 v67, v67, v15
    v_mfma_f32_16x16x32_bf16 v[100:103], v[232:235], v[196:199], v[100:103]
    s_waitcnt vmcnt(1)
    buffer_atomic_add v245, v244, s[12:15], s40 offen sc1
    s_add_u32 s40, s40, 65536
    v_exp_f32 v60, v60
    v_exp_f32 v61, v61
    v_mfma_f32_16x16x32_bf16 v[104:107], v[232:235], v[200:203], v[104:107]
    v_exp_f32 v62, v62
    v_exp_f32 v63, v63
    v_exp_f32 v64, v64
    v_mfma_f32_16x16x32_bf16 v[108:111], v[232:235], v[204:207], v[108:111]
    v_exp_f32 v65, v65
    v_exp_f32 v66, v66
    v_exp_f32 v67, v67
    v_mfma_f32_16x16x32_bf16 v[112:115], v[232:235], v[208:211], v[112:115]
    v_fma_f32 v60, v60, v18, v18
    v_fma_f32 v61, v61, v18, v18
    v_fma_f32 v62, v62, v18, v18
    v_fma_f32 v63, v63, v18, v18
    v_mfma_f32_16x16x32_bf16 v[84:87], v[236:239], v[212:215], v[84:87]
    v_fma_f32 v64, v64, v19, v19
    v_fma_f32 v65, v65, v19, v19
    v_fma_f32 v66, v66, v19, v19
    v_fma_f32 v67, v67, v19, v19
    v_rcp_f32 v60, v60
    v_mfma_f32_16x16x32_bf16 v[88:91], v[236:239], v[216:219], v[88:91]
    v_rcp_f32 v61, v61
    v_rcp_f32 v62, v62
    v_mfma_f32_16x16x32_bf16 v[92:95], v[236:239], v[220:223], v[92:95]
    v_rcp_f32 v63, v63
    v_rcp_f32 v64, v64
    v_rcp_f32 v65, v65
    v_mfma_f32_16x16x32_bf16 v[96:99], v[236:239], v[224:227], v[96:99]
    v_rcp_f32 v66, v66
    v_rcp_f32 v67, v67
    v_mfma_f32_16x16x32_bf16 v[100:103], v[240:243], v[212:215], v[100:103]
    v_mul_f32 v76, v76, v60
    v_mul_f32 v77, v77, v61
    v_mul_f32 v78, v78, v62
    v_mul_f32 v79, v79, v63
    v_mul_f32 v80, v80, v64
    v_mfma_f32_16x16x32_bf16 v[104:107], v[240:243], v[216:219], v[104:107]
    v_mul_f32 v81, v81, v65
    v_mul_f32 v82, v82, v66
    v_mul_f32 v83, v83, v67
    v_cvt_pk_bf16_f32 v60, v76, v77
    v_cvt_pk_bf16_f32 v62, v80, v81
    v_mfma_f32_16x16x32_bf16 v[108:111], v[240:243], v[220:223], v[108:111]
    v_cvt_pk_bf16_f32 v61, v78, v79
    v_cvt_pk_bf16_f32 v63, v82, v83
    v_permlane16_swap_b32 v60, v62
    s_nop 0
    v_permlane16_swap_b32 v61, v63
    buffer_store_dwordx4 v[60:63], v11, s[12:15], s37 offen sc1
    v_mfma_f32_16x16x32_bf16 v[112:115], v[240:243], v[224:227], v[112:115]
    s_addk_i32 s37, 16384
    v_pk_mul_f32 v[100:101], v[100:101], v[84:85]
    v_pk_mul_f32 v[102:103], v[102:103], v[86:87]
    v_pk_mul_f32 v[104:105], v[104:105], v[88:89]
    v_pk_mul_f32 v[106:107], v[106:107], v[90:91]
    v_pk_mul_f32 v[84:85], v[84:85], v[12:13] op_sel:[0,0] op_sel_hi:[1,0]
    v_pk_mul_f32 v[86:87], v[86:87], v[12:13] op_sel:[0,0] op_sel_hi:[1,0]
    v_pk_mul_f32 v[88:89], v[88:89], v[12:13] op_sel:[0,1] op_sel_hi:[1,1]
    v_pk_mul_f32 v[90:91], v[90:91], v[12:13] op_sel:[0,1] op_sel_hi:[1,1]
    v_exp_f32 v84, v84
    v_exp_f32 v85, v85
    v_exp_f32 v86, v86
    v_exp_f32 v87, v87
    v_exp_f32 v88, v88
    v_exp_f32 v89, v89
    v_exp_f32 v90, v90
    v_exp_f32 v91, v91
    v_pk_fma_f32 v[84:85], v[84:85], v[16:17], v[16:17] op_sel:[0,0,0] op_sel_hi:[1,0,0]
    v_pk_fma_f32 v[86:87], v[86:87], v[16:17], v[16:17] op_sel:[0,0,0] op_sel_hi:[1,0,0]
    v_pk_fma_f32 v[88:89], v[88:89], v[16:17], v[16:17] op_sel:[0,1,1] op_sel_hi:[1,1,1]
    v_pk_fma_f32 v[90:91], v[90:91], v[16:17], v[16:17] op_sel:[0,1,1] op_sel_hi:[1,1,1]
    v_rcp_f32 v84, v84
    v_rcp_f32 v85, v85
    v_rcp_f32 v86, v86
    v_rcp_f32 v87, v87
    v_rcp_f32 v88, v88
    v_rcp_f32 v89, v89
    v_rcp_f32 v90, v90
    v_rcp_f32 v91, v91
    v_pk_mul_f32 v[100:101], v[100:101], v[84:85]
    v_pk_mul_f32 v[102:103], v[102:103], v[86:87]
    v_pk_mul_f32 v[104:105], v[104:105], v[88:89]
    v_pk_mul_f32 v[106:107], v[106:107], v[90:91]
    v_cvt_pk_bf16_f32 v84, v100, v101
    v_cvt_pk_bf16_f32 v86, v104, v105
    v_cvt_pk_bf16_f32 v85, v102, v103
    v_cvt_pk_bf16_f32 v87, v106, v107
    v_permlane16_swap_b32 v84, v86
    s_nop 0
    v_permlane16_swap_b32 v85, v87
    buffer_store_dwordx4 v[84:87], v11, s[12:15], s36 offen sc1
    s_addk_i32 s36, 16384
    v_pk_mul_f32 v[108:109], v[108:109], v[92:93]
    v_pk_mul_f32 v[110:111], v[110:111], v[94:95]
    v_pk_mul_f32 v[112:113], v[112:113], v[96:97]
    v_pk_mul_f32 v[114:115], v[114:115], v[98:99]
    v_pk_mul_f32 v[92:93], v[92:93], v[14:15] op_sel:[0,0] op_sel_hi:[1,0]
    v_pk_mul_f32 v[94:95], v[94:95], v[14:15] op_sel:[0,0] op_sel_hi:[1,0]
    v_pk_mul_f32 v[96:97], v[96:97], v[14:15] op_sel:[0,1] op_sel_hi:[1,1]
    v_pk_mul_f32 v[98:99], v[98:99], v[14:15] op_sel:[0,1] op_sel_hi:[1,1]
    v_exp_f32 v92, v92
    v_exp_f32 v93, v93
    v_exp_f32 v94, v94
    v_exp_f32 v95, v95
    v_exp_f32 v96, v96
    v_exp_f32 v97, v97
    v_exp_f32 v98, v98
    v_exp_f32 v99, v99
    v_pk_fma_f32 v[92:93], v[92:93], v[18:19], v[18:19] op_sel:[0,0,0] op_sel_hi:[1,0,0]
    v_pk_fma_f32 v[94:95], v[94:95], v[18:19], v[18:19] op_sel:[0,0,0] op_sel_hi:[1,0,0]
    v_pk_fma_f32 v[96:97], v[96:97], v[18:19], v[18:19] op_sel:[0,1,1] op_sel_hi:[1,1,1]
    v_pk_fma_f32 v[98:99], v[98:99], v[18:19], v[18:19] op_sel:[0,1,1] op_sel_hi:[1,1,1]
    v_rcp_f32 v92, v92
    v_rcp_f32 v93, v93
    v_rcp_f32 v94, v94
    v_rcp_f32 v95, v95
    v_rcp_f32 v96, v96
    v_rcp_f32 v97, v97
    v_rcp_f32 v98, v98
    v_rcp_f32 v99, v99
    v_pk_mul_f32 v[108:109], v[108:109], v[92:93]
    v_pk_mul_f32 v[110:111], v[110:111], v[94:95]
    v_pk_mul_f32 v[112:113], v[112:113], v[96:97]
    v_pk_mul_f32 v[114:115], v[114:115], v[98:99]
    v_cvt_pk_bf16_f32 v92, v108, v109
    v_cvt_pk_bf16_f32 v94, v112, v113
    v_cvt_pk_bf16_f32 v93, v110, v111
    v_cvt_pk_bf16_f32 v95, v114, v115
    v_permlane16_swap_b32 v92, v94
    s_nop 0
    v_permlane16_swap_b32 v93, v95
    buffer_store_dwordx4 v[92:95], v11, s[12:15], s37 offen sc1
    s_addk_i32 s37, 16384
    s_waitcnt vmcnt(0)
    buffer_atomic_add v245, v244, s[12:15], s40 offen sc1
    s_add_u32 s40, s40, 65536
    s_cmp_lg_u32 s22, 1
    s_cbranch_scc1 L_block_kernel_po_102
    s_mov_b64 exec, 3
    v_mov_b32 v250, 0
    buffer_atomic_or v250, v6, s[12:15], s43 offen sc0 sc1
    s_movk_i32 s50, 20
L_block_kernel_pd_104:
    s_sub_u32 s50, s50, 1
    s_cbranch_scc0 L_block_kernel_pd_104
    s_movk_i32 s50, 20000
L_block_kernel_poll_101:
    v_mov_b32 v251, 0
    buffer_atomic_or v251, v6, s[12:15], s43 offen sc0 sc1
    s_waitcnt vmcnt(1)
    v_cmp_gt_u32 vcc, 16, v250
    s_cbranch_vccz L_block_kernel_pc_103
    v_mov_b32 v250, 0
    buffer_atomic_or v250, v6, s[12:15], s43 offen sc0 sc1
    s_waitcnt vmcnt(1)
    v_cmp_gt_u32 vcc, 16, v251
    s_cbranch_vccz L_block_kernel_pc_103
    s_sub_u32 s50, s50, 1
    s_cbranch_scc0 L_block_kernel_poll_101
L_block_kernel_pc_103:
    s_mov_b64 exec, -1
L_block_kernel_po_102:
    s_barrier
    s_barrier
    s_barrier
    s_endpgm
Hb_block_kernel_16:
    s_cbranch_execz Hb_block_kernel_17
L_block_kernel_side_105:
L_block_kernel_sd_64:
    s_movk_i32 s4, 20000
    s_mov_b64 exec, 7
Hb_block_kernel_17:
    s_cbranch_execz Hb_block_kernel_18
    s_branch L_block_kernel_pc_108
L_block_kernel_poll_106:
    v_mov_b32 v226, 0
    buffer_atomic_or v226, v227, s[12:15], s48 offen sc0 sc1
L_block_kernel_pc_108:
    s_sub_u32 s4, s4, 1
    s_cselect_b64 s[6:7], 0, -1
    s_waitcnt vmcnt(0)
    v_cmp_gt_u32 vcc, v228, v226
    s_nop 0
    s_and_b64 s[6:7], s[6:7], vcc
    s_cbranch_scc1 L_block_kernel_poll_106
    s_mov_b64 exec, -1
L_block_kernel_po_107:
    s_branch L_block_kernel_sr_65
L_block_kernel_sd_66:
    s_waitcnt vmcnt(0)
    buffer_atomic_add v229, v230, s[12:15], s48 offen sc1
Hb_block_kernel_18:
    s_cbranch_execz Hb_block_kernel_end
    s_branch L_block_kernel_sr_67
L_block_kernel_sd_68:
    s_waitcnt vmcnt(0)
    ds_read_b64_tr_b16 v[196:197], v234 offset:0
    ds_read_b64_tr_b16 v[198:199], v234 offset:256
    ds_read_b64_tr_b16 v[200:201], v235 offset:0
    ds_read_b64_tr_b16 v[202:203], v235 offset:256
    ds_read_b64_tr_b16 v[204:205], v236 offset:0
    ds_read_b64_tr_b16 v[206:207], v236 offset:256
Hb_block_kernel_seg4:
Hb_block_kernel_19:
    s_cbranch_execz Hb_block_kernel_20
    ds_read_b64_tr_b16 v[208:209], v237 offset:0
    ds_read_b64_tr_b16 v[210:211], v237 offset:256
    ds_read_b64_tr_b16 v[212:213], v238
    ds_read_b64_tr_b16 v[214:215], v239
    s_branch L_block_kernel_sr_69
L_block_kernel_sd_71:
    s_cmp_eq_u32 s46, 0
    s_cbranch_scc1 L_block_kernel_ns_109
    v_mfma_f32_16x16x32_bf16 v[222:225], v[218:221], v[196:199], 0
    v_mfma_f32_16x16x32_bf16 v[222:225], v[218:221], v[200:203], v[222:225]
Hb_block_kernel_20:
    s_cbranch_execz Hb_block_kernel_21
    v_mfma_f32_16x16x32_bf16 v[222:225], v[218:221], v[204:207], v[222:225]
    v_mfma_f32_16x16x32_bf16 v[222:225], v[218:221], v[208:211], v[222:225]
    v_mfma_f32_16x16x32_bf16 v[222:225], v[218:221], v[212:215], v[222:225]
    buffer_store_dwordx4 v[196:199], v216, s[12:15], s40 offen sc1
    buffer_store_dwordx4 v[200:203], v216, s[12:15], s41 offen sc1
    buffer_store_dwordx4 v[204:207], v216, s[12:15], s42 offen sc1
    buffer_store_dwordx4 v[208:211], v216, s[12:15], s43 offen sc1
    buffer_store_dwordx4 v[212:215], v216, s[12:15], s44 offen sc1
Hb_block_kernel_21:
    s_cbranch_execz Hb_block_kernel_22
    s_nop 2
    v_cvt_pk_bf16_f32 v223, v222, v222
    v_and_b32 v224, 0xffff0000, v223
    v_sub_f32 v224, v222, v224
    v_cvt_pk_bf16_f32 v223, v222, v224
    buffer_store_dword v223, v217, s[12:15], s45 offen sc1
    s_branch L_block_kernel_sr_72
L_block_kernel_ns_109:
    buffer_store_dwordx4 v[196:199], v216, s[12:15], s40 offen sc1
    buffer_store_dwordx4 v[200:203], v216, s[12:15], s41 offen sc1
Hb_block_kernel_22:
    s_cbranch_execz Hb_block_kernel_23
    buffer_store_dwordx4 v[204:207], v216, s[12:15], s42 offen sc1
    buffer_store_dwordx4 v[208:211], v216, s[12:15], s43 offen sc1
    buffer_store_dwordx4 v[212:215], v216, s[12:15], s44 offen sc1
    s_branch L_block_kernel_sr_72
L_block_kernel_sd_74:
    s_add_u32 m0, s9, 0
    s_nop 0
    buffer_load_dwordx4 v232, s[16:19], s4 offen lds
    s_add_u32 m0, s9, 1024
    s_nop 0
Hb_block_kernel_23:
    s_cbranch_execz Hb_block_kernel_24
    buffer_load_dwordx4 v232, s[16:19], s5 offen lds
    s_add_u32 m0, s9, 2048
    s_nop 0
    buffer_load_dwordx4 v232, s[16:19], s6 offen lds
    s_add_u32 m0, s9, 3072
    s_nop 0
    buffer_load_dwordx4 v232, s[16:19], s7 offen lds
    s_add_u32 m0, s9, 4096
    s_nop 0
Hb_block_kernel_24:
    s_cbranch_execz Hb_block_kernel_25
    buffer_load_dwordx4 v233, s[16:19], s8 offen lds
    s_branch L_block_kernel_sr_75
L_block_kernel_fb_90:
    s_movk_i32 s50, 40
L_block_kernel_ft_110:
    v_lshlrev_b32 v100, 16, v204
    v_and_b32 v101, 0xffff0000, v204
    v_lshlrev_b32 v102, 16, v205
    v_and_b32 v103, 0xffff0000, v205
    v_lshlrev_b32 v104, 16, v206
    v_and_b32 v105, 0xffff0000, v206
    v_lshlrev_b32 v106, 16, v207
    v_and_b32 v107, 0xffff0000, v207
Hb_block_kernel_25:
    s_cbranch_execz Hb_block_kernel_end
    v_lshlrev_b32 v108, 16, v208
    v_and_b32 v109, 0xffff0000, v208
    v_lshlrev_b32 v110, 16, v209
    v_and_b32 v111, 0xffff0000, v209
    v_lshlrev_b32 v112, 16, v210
    v_and_b32 v113, 0xffff0000, v210
    v_lshlrev_b32 v114, 16, v211
    v_and_b32 v115, 0xffff0000, v211
    v_lshlrev_b32 v116, 16, v212
    v_and_b32 v117, 0xffff0000, v212
Hb_block_kernel_seg5:
Hb_block_kernel_26:
    s_cbranch_execz Hb_block_kernel_27
    v_lshlrev_b32 v118, 16, v213
    v_and_b32 v119, 0xffff0000, v213
    s_mul_i32 s25, s20, 20480
    s_add_u32 s25, s25, 12582912
    s_mul_i32 s29, s21, 102400
    s_add_u32 s29, s29, 29360128
    s_mov_b32 s30, 0
    v_mov_b32 v217, v8
    v_add_u32 v218, 8, v8
Hb_block_kernel_27:
    s_cbranch_execz Hb_block_kernel_28
L_block_kernel_fk_111:
    v_mov_b32 v20, 0
    v_mov_b32 v21, 0
    v_mov_b32 v22, 0
    v_mov_b32 v23, 0
    buffer_atomic_or_x2 v[20:21], v217, s[12:15], s25 offen sc0 sc1
    buffer_atomic_or_x2 v[22:23], v218, s[12:15], s25 offen sc0 sc1
    buffer_load_dwordx4 v[164:167], v8, s[12:15], s29 offen sc1
    s_addk_i32 s29, 1024
    buffer_load_dwordx4 v[168:171], v8, s[12:15], s29 offen sc1
    s_addk_i32 s29, 1024
    buffer_load_dwordx4 v[172:175], v8, s[12:15], s29 offen sc1
Hb_block_kernel_28:
    s_cbranch_execz Hb_block_kernel_29
    s_addk_i32 s29, 1024
    buffer_load_dwordx4 v[176:179], v8, s[12:15], s29 offen sc1
    s_addk_i32 s29, 1024
    buffer_load_dwordx4 v[180:183], v8, s[12:15], s29 offen sc1
    s_addk_i32 s29, 1024
    s_waitcnt vmcnt(0)
    v_mfma_f32_16x16x32_bf16 v[100:103], v[164:167], v[20:23], v[100:103]
    v_mfma_f32_16x16x32_bf16 v[104:107], v[168:171], v[20:23], v[104:107]
    v_mfma_f32_16x16x32_bf16 v[108:111], v[172:175], v[20:23], v[108:111]
Hb_block_kernel_29:
    s_cbranch_execz Hb_block_kernel_30
    v_mfma_f32_16x16x32_bf16 v[112:115], v[176:179], v[20:23], v[112:115]
    v_mfma_f32_16x16x32_bf16 v[116:119], v[180:183], v[20:23], v[116:119]
    s_nop 7
    s_nop 7
    s_addk_i32 s25, 1024
    s_add_u32 s30, s30, 1
    s_cmp_lg_u32 s30, 16
    s_cbranch_scc1 L_block_kernel_fs_112
    v_mov_b32 v217, v219
    v_add_u32 v218, 256, v219
L_block_kernel_fs_112:
    s_cmp_lt_u32 s30, 20
    s_cbranch_scc1 L_block_kernel_fk_111
Hb_block_kernel_30:
    s_cbranch_execz Hb_block_kernel_31
    v_cmp_u_f32 vcc, v100, v100
    s_cbranch_vccz L_block_kernel_fr_91
    s_sub_u32 s50, s50, 1
    s_cbranch_scc0 L_block_kernel_ft_110
    s_branch L_block_kernel_fr_91
L_block_kernel_gf_97:
    s_movk_i32 s30, 40
L_block_kernel_gt_114:
    s_waitcnt lgkmcnt(0)
    s_nop 7
    s_nop 7
    s_sub_u32 s25, s26, 65536
    v_and_b32 v5, 0x1ff, v8
    v_mov_b32 v196, 0
    v_mov_b32 v197, 0
Hb_block_kernel_31:
    s_cbranch_execz Hb_block_kernel_end
    v_mov_b32 v198, 0
    v_mov_b32 v199, 0
    v_mov_b32 v200, 0
    v_mov_b32 v201, 0
    v_mov_b32 v202, 0
    v_mov_b32 v203, 0
    v_mov_b32 v204, 0
    v_mov_b32 v205, 0
    v_mov_b32 v206, 0
    v_mov_b32 v207, 0
    v_mov_b32 v208, 0
    v_mov_b32 v209, 0
    v_mov_b32 v210, 0
    v_mov_b32 v211, 0
    buffer_atomic_or_x2 v[196:197], v1, s[12:15], s25 offen offset:0 sc0 sc1
Hb_block_kernel_seg6:
Hb_block_kernel_32:
    s_cbranch_execz Hb_block_kernel_33
    buffer_atomic_or_x2 v[198:199], v1, s[12:15], s26 offen offset:0 sc0 sc1
    buffer_atomic_or_x2 v[200:201], v1, s[12:15], s25 offen offset:128 sc0 sc1
    buffer_atomic_or_x2 v[202:203], v1, s[12:15], s26 offen offset:128 sc0 sc1
    buffer_atomic_or_x2 v[204:205], v1, s[12:15], s25 offen offset:256 sc0 sc1
    buffer_atomic_or_x2 v[206:207], v1, s[12:15], s26 offen offset:256 sc0 sc1
    buffer_atomic_or_x2 v[208:209], v1, s[12:15], s25 offen offset:384 sc0 sc1
    buffer_atomic_or_x2 v[210:211], v1, s[12:15], s26 offen offset:384 sc0 sc1
Hb_block_kernel_33:
    s_cbranch_execz Hb_block_kernel_34
    buffer_load_dwordx4 v[140:143], v5, s[12:15], s24 offen offset:0 sc1
    buffer_load_dwordx4 v[144:147], v5, s[12:15], s24 offen offset:512 sc1
    buffer_load_dwordx4 v[148:151], v5, s[12:15], s24 offen offset:1024 sc1
    buffer_load_dwordx4 v[152:155], v5, s[12:15], s24 offen offset:1536 sc1
    buffer_load_dwordx4 v[156:159], v5, s[12:15], s24 offen offset:2048 sc1
    buffer_load_dwordx4 v[160:163], v5, s[12:15], s24 offen offset:2560 sc1
    s_branch L_block_kernel_gs_95
L_block_kernel_gb_96:
    s_and_b32 s27, s23, 1
    s_mul_i32 s27, s27, 3072
Hb_block_kernel_34:
    s_cbranch_execz Hb_block_kernel_35
    s_add_u32 s27, s27, s24
    s_add_u32 s27, s27, 6144
    s_mul_i32 s25, s48, 81920
    s_add_u32 s25, s25, 16777216
    s_mov_b32 s28, 0
L_block_kernel_gk_113:
    v_mov_b32 v164, 0
    v_mov_b32 v165, 0
    v_mov_b32 v166, 0
    v_mov_b32 v167, 0
    v_mov_b32 v168, 0
    v_mov_b32 v169, 0
Hb_block_kernel_35:
    s_cbranch_execz Hb_block_kernel_36
    v_mov_b32 v170, 0
    v_mov_b32 v171, 0
    v_mov_b32 v172, 0
    v_mov_b32 v173, 0
    v_mov_b32 v174, 0
    v_mov_b32 v175, 0
    v_mov_b32 v176, 0
    v_mov_b32 v177, 0
    v_mov_b32 v178, 0
    v_mov_b32 v179, 0
    buffer_atomic_or_x2 v[164:165], v8, s[12:15], s25 offen offset:0 sc0 sc1
    buffer_atomic_or_x2 v[166:167], v8, s[12:15], s25 offen offset:8 sc0 sc1
    s_add_u32 s25, s25, 20480
Hb_block_kernel_36:
    s_cbranch_execz Hb_block_kernel_37
    buffer_atomic_or_x2 v[168:169], v8, s[12:15], s25 offen offset:0 sc0 sc1
    buffer_atomic_or_x2 v[170:171], v8, s[12:15], s25 offen offset:8 sc0 sc1
    s_add_u32 s25, s25, 20480
    buffer_atomic_or_x2 v[172:173], v8, s[12:15], s25 offen offset:0 sc0 sc1
    buffer_atomic_or_x2 v[174:175], v8, s[12:15], s25 offen offset:8 sc0 sc1
    s_add_u32 s25, s25, 20480
    buffer_atomic_or_x2 v[176:177], v8, s[12:15], s25 offen offset:0 sc0 sc1
Hb_block_kernel_37:
    s_cbranch_execz Hb_block_kernel_38
    buffer_atomic_or_x2 v[178:179], v8, s[12:15], s25 offen offset:8 sc0 sc1
    s_add_u32 s25, s25, -60416
    buffer_load_dwordx4 v[116:119], v8, s[12:15], s27 offen sc1
    s_addk_i32 s27, 1024
    buffer_load_dwordx4 v[120:123], v8, s[12:15], s27 offen sc1
    s_addk_i32 s27, 1024
    buffer_load_dwordx4 v[124:127], v8, s[12:15], s27 offen sc1
    s_addk_i32 s27, 1024
    buffer_load_dwordx4 v[128:131], v8, s[12:15], s27 offen sc1
Hb_block_kernel_38:
    s_cbranch_execz Hb_block_kernel_end
    s_addk_i32 s27, 1024
    buffer_load_dwordx4 v[132:135], v8, s[12:15], s27 offen sc1
    s_addk_i32 s27, 1024
    buffer_load_dwordx4 v[136:139], v8, s[12:15], s27 offen sc1
    s_addk_i32 s27, 7168
    s_waitcnt vmcnt(0)
    v_mfma_f32_16x16x32_bf16 v[20:23], v[116:119], v[164:167], v[20:23]
    v_mfma_f32_16x16x32_bf16 v[24:27], v[116:119], v[168:171], v[24:27]
    v_mfma_f32_16x16x32_bf16 v[28:31], v[116:119], v[172:175], v[28:31]
    v_mfma_f32_16x16x32_bf16 v[32:35], v[116:119], v[176:179], v[32:35]
Hb_block_kernel_seg7:
Hb_block_kernel_39:
    s_cbranch_execz Hb_block_kernel_40
    v_mfma_f32_16x16x32_bf16 v[36:39], v[120:123], v[164:167], v[36:39]
    v_mfma_f32_16x16x32_bf16 v[40:43], v[120:123], v[168:171], v[40:43]
    v_mfma_f32_16x16x32_bf16 v[44:47], v[120:123], v[172:175], v[44:47]
    v_mfma_f32_16x16x32_bf16 v[48:51], v[120:123], v[176:179], v[48:51]
    v_mfma_f32_16x16x32_bf16 v[52:55], v[124:127], v[164:167], v[52:55]
    v_mfma_f32_16x16x32_bf16 v[56:59], v[124:127], v[168:171], v[56:59]
    v_mfma_f32_16x16x32_bf16 v[60:63], v[124:127], v[172:175], v[60:63]
Hb_block_kernel_40:
    s_cbranch_execz Hb_block_kernel_41
    v_mfma_f32_16x16x32_bf16 v[64:67], v[124:127], v[176:179], v[64:67]
    v_mfma_f32_16x16x32_bf16 v[68:71], v[128:131], v[164:167], v[68:71]
    v_mfma_f32_16x16x32_bf16 v[72:75], v[128:131], v[168:171], v[72:75]
    v_mfma_f32_16x16x32_bf16 v[76:79], v[128:131], v[172:175], v[76:79]
    v_mfma_f32_16x16x32_bf16 v[80:83], v[128:131], v[176:179], v[80:83]
    v_mfma_f32_16x16x32_bf16 v[84:87], v[132:135], v[164:167], v[84:87]
    v_mfma_f32_16x16x32_bf16 v[88:91], v[132:135], v[168:171], v[88:91]
    v_mfma_f32_16x16x32_bf16 v[92:95], v[132:135], v[172:175], v[92:95]
Hb_block_kernel_41:
    s_cbranch_execz Hb_block_kernel_42
    v_mfma_f32_16x16x32_bf16 v[96:99], v[132:135], v[176:179], v[96:99]
    v_mfma_f32_16x16x32_bf16 v[100:103], v[136:139], v[164:167], v[100:103]
    v_mfma_f32_16x16x32_bf16 v[104:107], v[136:139], v[168:171], v[104:107]
    v_mfma_f32_16x16x32_bf16 v[108:111], v[136:139], v[172:175], v[108:111]
    v_mfma_f32_16x16x32_bf16 v[112:115], v[136:139], v[176:179], v[112:115]
    s_nop 7
    s_nop 7
    s_add_u32 s28, s28, 1
    s_cmp_lt_u32 s28, 20
Hb_block_kernel_42:
    s_cbranch_execz Hb_block_kernel_43
    s_cbranch_scc1 L_block_kernel_gk_113
    v_mov_b64 v[164:165], 0
    v_mov_b64 v[166:167], 0
    v_mov_b64 v[168:169], 0
    v_mov_b64 v[170:171], 0
    v_mov_b64 v[172:173], 0
    v_mov_b64 v[174:175], 0
    v_mov_b64 v[176:177], 0
    v_mov_b64 v[178:179], 0
    v_mov_b64 v[180:181], 0
    v_mov_b64 v[182:183], 0
    v_mov_b64 v[184:185], 0
    v_mov_b64 v[186:187], 0
    v_mov_b64 v[188:189], 0
    v_mov_b64 v[190:191], 0
Hb_block_kernel_43:
    s_cbranch_execz Hb_block_kernel_44
    v_mov_b64 v[192:193], 0
    v_mov_b64 v[194:195], 0
    v_mov_b64 v[196:197], 0
    v_mov_b64 v[198:199], 0
    v_mov_b64 v[200:201], 0
    v_mov_b64 v[202:203], 0
    v_mov_b64 v[204:205], 0
    v_mov_b64 v[206:207], 0
    v_mov_b64 v[208:209], 0
    v_mov_b64 v[210:211], 0
    v_mov_b64 v[212:213], 0
    v_mov_b64 v[214:215], 0
    v_mov_b64 v[216:217], 0
    v_mov_b64 v[218:219], 0
    v_mov_b64 v[220:221], 0
Hb_block_kernel_44:
    s_cbranch_execz Hb_block_kernel_end
    v_mov_b64 v[222:223], 0
    v_mov_b64 v[224:225], 0
    v_mov_b64 v[226:227], 0
    v_cmp_u_f32 vcc, v20, v24
    v_cmp_u_f32 s[28:29], v28, v32
    s_or_b64 s[28:29], s[28:29], vcc
    s_cbranch_scc0 L_block_kernel_gr_98
    s_sub_u32 s30, s30, 1
    s_cmp_lg_u32 s30, 0
    s_cbranch_scc1 L_block_kernel_gt_114
    s_branch L_block_kernel_gr_98
L_block_kernel_slow_56:
    v_mov_b32 v178, 0
    v_mov_b32 v179, 0
    v_mul_u32_u24 v20, 320, v4
    v_lshl_add_u32 v20, v3, 4, v20
    v_permlane32_swap_b32 v16, v178
    v_permlane32_swap_b32 v17, v179
    s_mov_b32 s38, 1
L_block_kernel_s0_117:
    v_swap_b32 v16, v178
    v_swap_b32 v17, v179
    v_swap_b32 v8, v12
    v_swap_b32 v9, v13
    v_swap_b32 v10, v14
    v_swap_b32 v11, v15
    v_mov_b32 v152, v136
    v_mov_b32 v153, v137
    v_mov_b32 v154, v138
    v_mov_b32 v155, v139
    v_mov_b32 v156, v140
    v_mov_b32 v157, v141
    v_mov_b32 v158, v142
    v_mov_b32 v159, v143
    v_mov_b32 v160, v144
    v_mov_b32 v161, v145
    v_mov_b32 v162, v146
    v_mov_b32 v163, v147
    v_mov_b32 v6, 0xff800000
    s_mov_b32 s37, s31
    s_mov_b32 s36, 0
L_block_kernel_s1_115:
    s_bitcmp1_b32 s36, 0
    s_cselect_b32 s6, 2808, 0
    s_cselect_b32 s7, 0, 512
    s_sub_u32 s6, s37, s6
    buffer_load_dwordx4 v[168:171], v21, s[12:15], s37 offen sc1
    buffer_load_dwordx2 v[176:177], v5, s[12:15], s6 offen sc1
    s_waitcnt vmcnt(0)
    v_mfma_f32_32x32x16_bf16 v[56:71], v[168:171], v[8:11], 0
    v_mfma_f32_32x32x8_bf16 v[56:71], v[176:177], v[16:17], v[56:71]
    s_nop 11
    v_max3_f32 v6, v6, v56, v57
    v_max3_f32 v6, v6, v58, v59
    v_max3_f32 v6, v6, v60, v61
    v_max3_f32 v6, v6, v62, v63
    v_max3_f32 v6, v6, v64, v65
    v_max3_f32 v6, v6, v66, v67
    v_max3_f32 v6, v6, v68, v69
    v_max3_f32 v6, v6, v70, v71
    s_add_u32 s37, s37, s7
    s_addk_i32 s37, 2304
    s_add_u32 s36, s36, 1
    s_cmp_lt_u32 s36, 64
    s_cbranch_scc1 L_block_kernel_s1_115
    v_mov_b32 v7, v6
    s_nop 1
    v_permlane32_swap_b32 v6, v7
    v_max_f32 v6, v6, v7
    v_sub_f32 v24, 0, v6
    v_sub_f32 v25, 0, v6
    v_sub_f32 v26, 0, v6
    v_sub_f32 v27, 0, v6
    v_sub_f32 v28, 0, v6
    v_sub_f32 v29, 0, v6
    v_sub_f32 v30, 0, v6
    v_sub_f32 v31, 0, v6
    v_sub_f32 v32, 0, v6
    v_sub_f32 v33, 0, v6
    v_sub_f32 v34, 0, v6
    v_sub_f32 v35, 0, v6
    v_sub_f32 v36, 0, v6
    v_sub_f32 v37, 0, v6
    v_sub_f32 v38, 0, v6
    v_sub_f32 v39, 0, v6
    v_mov_b32 v136, 0
    v_mov_b32 v137, 0
    v_mov_b32 v138, 0
    v_mov_b32 v139, 0
    v_mov_b32 v140, 0
    v_mov_b32 v141, 0
    v_mov_b32 v142, 0
    v_mov_b32 v143, 0
    v_mov_b32 v144, 0
    v_mov_b32 v145, 0
    v_mov_b32 v146, 0
    v_mov_b32 v147, 0
    v_mov_b32 v148, 0
    v_mov_b32 v149, 0
    v_mov_b32 v150, 0
    v_mov_b32 v151, 0
    s_mov_b32 s37, s31
    s_mov_b32 s36, 0
L_block_kernel_s2_116:
    s_bitcmp1_b32 s36, 0
    s_cselect_b32 s6, 2808, 0
    s_cselect_b32 s7, 0, 512
    s_sub_u32 s6, s37, s6
    buffer_load_dwordx4 v[168:171], v21, s[12:15], s37 offen sc1
    buffer_load_dwordx2 v[176:177], v5, s[12:15], s6 offen sc1
    s_mov_b64 exec, s[50:51]
    buffer_load_dwordx4 v[180:183], v20, s[12:15], s37 offen offset:1024 sc1
    buffer_load_dwordx4 v[184:187], v20, s[12:15], s37 offen offset:1664 sc1
    s_mov_b64 exec, -1
    s_waitcnt vmcnt(0)
    v_mfma_f32_32x32x16_bf16 v[56:71], v[168:171], v[8:11], v[24:39]
    v_mfma_f32_32x32x8_bf16 v[56:71], v[176:177], v[16:17], v[56:71]
    s_nop 11
    v_exp_f32 v56, v56
    v_exp_f32 v57, v57
    v_exp_f32 v58, v58
    v_exp_f32 v59, v59
    v_exp_f32 v60, v60
    v_exp_f32 v61, v61
    v_exp_f32 v62, v62
    v_exp_f32 v63, v63
    v_exp_f32 v64, v64
    v_exp_f32 v65, v65
    v_exp_f32 v66, v66
    v_exp_f32 v67, v67
    v_exp_f32 v68, v68
    v_exp_f32 v69, v69
    v_exp_f32 v70, v70
    v_exp_f32 v71, v71
    v_cvt_pk_bf16_f32 v120, v56, v57
    v_cvt_pk_bf16_f32 v121, v58, v59
    v_cvt_pk_bf16_f32 v122, v60, v61
    v_cvt_pk_bf16_f32 v123, v62, v63
    v_cvt_pk_bf16_f32 v124, v64, v65
    v_cvt_pk_bf16_f32 v125, v66, v67
    v_cvt_pk_bf16_f32 v126, v68, v69
    v_cvt_pk_bf16_f32 v127, v70, v71
    v_mfma_f32_32x32x16_bf16 v[136:151], v[180:183], v[120:123], v[136:151]
    s_nop 0
    v_mfma_f32_32x32x16_bf16 v[136:151], v[184:187], v[124:127], v[136:151]
    s_add_u32 s37, s37, s7
    s_addk_i32 s37, 2304
    s_add_u32 s36, s36, 1
    s_cmp_lt_u32 s36, 64
    s_cbranch_scc1 L_block_kernel_s2_116
    s_sub_u32 s38, s38, 1
    s_cbranch_scc0 L_block_kernel_s0_117
    v_mov_b32 v56, 0
    v_mov_b32 v57, 0
    v_mov_b32 v58, 0
    v_mov_b32 v59, 0
    v_mov_b32 v60, 0
    v_mov_b32 v61, 0
    v_mov_b32 v62, 0
    v_mov_b32 v63, 0
    v_mov_b32 v64, 0
    v_mov_b32 v65, 0
    v_mov_b32 v66, 0
    v_mov_b32 v67, 0
    v_mov_b32 v72, 0
    v_mov_b32 v73, 0
    v_mov_b32 v74, 0
    v_mov_b32 v75, 0
    v_mov_b32 v76, 0
    v_mov_b32 v77, 0
    v_mov_b32 v78, 0
    v_mov_b32 v79, 0
    v_mov_b32 v80, 0
    v_mov_b32 v81, 0
    v_mov_b32 v82, 0
    v_mov_b32 v83, 0
    s_branch L_block_kernel_epi_55
L_block_kernel_end_4:
    s_endpgm
.section .rodata,"a"
.p2align 6
.amdhsa_kernel block_kernel
  .amdhsa_next_free_vgpr 256
  .amdhsa_next_free_sgpr 102
  .amdhsa_accum_offset 256
  .amdhsa_group_segment_fixed_size 0
  .amdhsa_kernarg_size 80
  .amdhsa_user_sgpr_count 2
  .amdhsa_user_sgpr_kernarg_segment_ptr 1
  .amdhsa_system_sgpr_workgroup_id_x 1
.end_amdhsa_kernel
.text
code_end:
    s_endpgm
```
